```python
import torch

def _softmax(x, axis=-1):
    return torch.softmax(x, dim=axis)
def _gelu(x):
    return torch.nn.functional.gelu(x, approximate="tanh")
def _silu(x):
    return torch.nn.functional.silu(x)
def _sigmoid(x):
    return torch.sigmoid(x)
def _layernorm(x, axis=-1, eps=1e-5):
    m = x.mean(dim=axis, keepdim=True)
    v = x.var(dim=axis, keepdim=True, unbiased=False)
    return (x - m) / torch.sqrt(v + eps)
def _scatter_add(tgt, idx, src, axis=0):
    return tgt.clone().index_add_(axis, idx, src)
def _segment_sum(src, seg, n):
    out = torch.zeros((n,) + src.shape[1:], dtype=src.dtype)
    return out.index_add_(0, seg, src)
def _pad(x, pw):
    flat = tuple(v for pair in reversed(pw) for v in pair)
    return torch.nn.functional.pad(x, flat)

kernel_name = 'sequential_preLN__ssm_conv_s4d__mixer_s_mlp__prompt'

def setup_inputs():

    _w = (lambda a: (lambda t: t.to(torch.bfloat16) if t.is_floating_point() else t)(torch.as_tensor(a)))
    def _A_setup():
        Bsz, L, D, N = 1, 2048, 448, 256
        return {
            "u": _w((lambda *s: torch.randn(*s, dtype=torch.bfloat16) * 0.05)(Bsz, L, D)),
            "log_A_real": _w((lambda *s: torch.randn(*s, dtype=torch.bfloat16) * 6.4)(D, N) * 0.5),
            "A_imag": _w((lambda *s: torch.randn(*s, dtype=torch.bfloat16) * 0.05)(D, N) * 3.14),
            "C_real": _w((lambda *s: torch.randn(*s, dtype=torch.bfloat16) * 0.05)(D, N) / N ** 0.5),
            "C_imag": _w((lambda *s: torch.randn(*s, dtype=torch.bfloat16) * 0.05)(D, N) / N ** 0.5),
            "log_dt": _w((lambda *s: torch.randn(*s, dtype=torch.bfloat16) * 0.05)(D) * 0.5 - 4.0),
            "D_skip": _w((lambda *s: torch.randn(*s, dtype=torch.bfloat16) * 0.05)(D)),
        }
    _A_in = _A_setup()

    def _B_setup():
        B, S, D, F = 1, 2048, 448, 1792
        return {
            "x":  _w((lambda *s: torch.randn(*s, dtype=torch.bfloat16) * 0.05)(B, S, D)),
            "w1": _w((lambda *s: torch.randn(*s, dtype=torch.bfloat16) * 6.4)(D, D) * (D ** -0.5)),
            "w2": _w((lambda *s: torch.randn(*s, dtype=torch.bfloat16) * 6.4)(D, D) * (D ** -0.5)),
            "w3": _w((lambda *s: torch.randn(*s, dtype=torch.bfloat16) * 6.4)(D, F) * (D ** -0.5)),
            "w4": _w((lambda *s: torch.randn(*s, dtype=torch.bfloat16) * 3.2)(F, D) * (F ** -0.5)),
        }
    _B_in = _B_setup()

    return {
        "A_u": _A_in["u"],
        "A_log_A_real": _A_in["log_A_real"],
        "A_A_imag": _A_in["A_imag"],
        "A_C_real": _A_in["C_real"],
        "A_C_imag": _A_in["C_imag"],
        "A_log_dt": _A_in["log_dt"],
        "A_D_skip": _A_in["D_skip"],
        "B_x": _B_in["x"],
        "B_w1": _B_in["w1"],
        "B_w2": _B_in["w2"],
        "B_w3": _B_in["w3"],
        "B_w4": _B_in["w4"],
    }

def reference(A_u, A_log_A_real, A_A_imag, A_C_real, A_C_imag, A_log_dt, A_D_skip, B_x, B_w1, B_w2, B_w3, B_w4):
    def _A_ref(u, log_A_real, A_imag, C_real, C_imag, log_dt, D_skip):
        L = u.shape[1]
        dt = torch.exp(log_dt)
        A = -torch.exp(log_A_real) + 1j * A_imag
        C = (C_real + 1j * C_imag) * dt[:, None]
        pos = (lambda x, dt: x.to(dt))(torch.arange(L), log_dt.dtype)
        P = torch.exp((A * dt[:, None])[:, :, None] * pos[None, None, :])
        K = 2.0 * torch.einsum("dn,dnl->dl", C, P).real
        L2 = 2 * L
        u_t = (lambda x, *d: x.permute(*d))(u, 0, 2, 1)
        Kf = (lambda x, *a, **k: torch.fft.rfft(x.float(), *a, **k))(K, L2)
        Uf = (lambda x, *a, **k: torch.fft.rfft(x.float(), *a, **k))(u_t, L2)
        y = (lambda x, *a, **k: torch.fft.irfft(x, *a, **k).to(torch.bfloat16))(Uf * Kf[None, :, :], L2)[:, :, :L]
        y = (lambda x, *d: x.permute(*d))(y, 0, 2, 1)
        return y + u * D_skip[None, None, :]

    def _B_ref(x, w1, w2, w3, w4):
        B, S, D = x.shape
        h = _gelu(_layernorm(x, axis=-1) @ w1)
        c = D // 4
        g0 = _pad(h[:, :, 0*c:1*c], ((0, 0), (1, 0), (0, 0)))[:, :S, :]
        g1 = _pad(h[:, :, 1*c:2*c], ((0, 0), (0, 1), (0, 0)))[:, 1:, :]
        g2 = _pad(h[:, :, 2*c:3*c], ((0, 0), (2, 0), (0, 0)))[:, :S, :]
        g3 = _pad(h[:, :, 3*c:   ], ((0, 0), (0, 2), (0, 0)))[:, 2:, :]
        hs = torch.concatenate([g0, g1, g2, g3], axis=-1) @ w2
        x1 = x + hs
        h2 = _gelu(_layernorm(x1, axis=-1) @ w3) @ w4
        return x1 + h2

    x = A_u
    h = x + _A_ref(_layernorm(x, axis=-1), A_log_A_real, A_A_imag, A_C_real, A_C_imag, A_log_dt, A_D_skip)
    h2 = h + _B_ref(_layernorm(h, axis=-1), B_w1, B_w2, B_w3, B_w4)
    return h2
```

```asm
; @launch grid=(256,1,1) block=(512,1,1) lds=153600
.amdgcn_target "amdgcn-amd-amdhsa--gfx950"
.text
.globl sequential_preLN__ssm_conv_s4d__mixer_s_mlp__prompt_kernel
.p2align 8
.type sequential_preLN__ssm_conv_s4d__mixer_s_mlp__prompt_kernel,@function
sequential_preLN__ssm_conv_s4d__mixer_s_mlp__prompt_kernel:
    s_cmp_ge_u32 s2, 256
    s_cbranch_scc1 Lend
    s_load_dwordx16 s[4:19], s[0:1], 0
    s_load_dwordx8 s[20:27], s[0:1], 64
    s_load_dwordx2 s[28:29], s[0:1], 96
    s_load_dwordx2 s[30:31], s[0:1], 112
    s_getpc_b64 s[94:95]
Lpc:
    s_lshr_b32 s54, s2, 3
    v_lshrrev_b32 v4, 6, v0
    v_and_b32 v2, 63, v0
    v_lshl_add_u32 v7, v0, 5, s54
    v_lshlrev_b32 v7, 7, v7
    v_cmp_gt_u32 vcc, 30796, v7
    s_nop 1
    s_and_saveexec_b64 s[70:71], vcc
    s_cbranch_execz Lcp1
    global_load_dword v255, v7, s[94:95]
Lcp1:
    s_mov_b64 exec, -1
    v_readfirstlane_b32 s52, v4
    v_lshlrev_b32 v1, 4, v2
    s_add_u32 s94, s94, 24528
    s_addc_u32 s95, s95, 0
    s_lshl_b32 s69, s2, 6
    s_add_u32 s69, s69, 6272
    v_lshl_add_u32 v5, v4, 3, s69
    global_load_dwordx2 v[84:85], v5, s[94:95]
    global_load_dwordx4 v[80:83], v1, s[94:95] offset:1024
    global_load_dwordx4 v[76:79], v1, s[94:95]
    s_lshl3_add_u32 s68, s2, s52
    v_and_b32 v6, 255, v0
    v_lshlrev_b32 v18, 4, v6
    global_load_dwordx4 v[66:69], v18, s[94:95] offset:2048
    global_load_ushort v70, v18, s[94:95] offset:2064
    s_and_b32 s53, s2, 7
    s_mul_i32 s55, s53, 28
    s_add_u32 s55, s55, s54
    s_min_u32 s55, s55, 223
    s_lshl_b32 s70, s55, 10
    v_lshl_add_u32 v64, v0, 1, s70
    s_mul_i32 s73, s68, 896
    s_mov_b32 s38, 896
    s_mov_b32 s39, 0x20000
    s_mov_b32 s47, 0x20000
    s_mov_b32 s34, 67108864
    s_mov_b32 s35, 0x20000
    s_lshl_b32 s93, s52, 11
    s_add_u32 s93, s93, 119296
    s_lshl_b32 s71, s55, 2
    s_mov_b32 s72, 33685504
    s_waitcnt lgkmcnt(0)
    s_add_u32 s36, s4, s73
    s_addc_u32 s37, s5, 0
    buffer_load_dwordx4 v[28:31], v1, s[36:39], 0 offen
    s_load_dword s56, s[30:31], s72
    s_load_dword s40, s[14:15], s71
    s_load_dword s42, s[16:17], s71
    global_load_ushort v60, v64, s[6:7]
    global_load_ushort v61, v64, s[8:9]
    global_load_ushort v62, v64, s[10:11]
    global_load_ushort v63, v64, s[12:13]
    s_waitcnt vmcnt(9)
    v_readfirstlane_b32 s90, v84
    v_readfirstlane_b32 s91, v85
    s_nop 0
    s_lshr_b32 s43, s90, 24
    s_and_b32 s90, s90, 0xffffff
    s_bitcmp1_b32 s43, 0
    s_cselect_b64 s[20:21], s[22:23], s[20:21]
    s_cselect_b64 s[24:25], s[26:27], s[24:25]
    s_cmp_eq_u32 s43, 2
    s_cselect_b64 vcc, -1, 0
    s_movk_i32 s89, 896
    s_cmovk_i32 s89, 3584
    s_cmp_lt_u32 s43, 2
    s_cselect_b64 s[44:45], s[20:21], s[24:25]
    s_cselect_b32 s46, 401408, 0
    s_cselect_b64 s[72:73], -1, 0
    s_lshl4_add_u32 s89, s89, s90
    s_mov_b32 s32, s30
    s_mov_b32 s33, s31
    s_waitcnt vmcnt(8)
    v_cndmask_b32_sdwa v23, v81, v82, vcc dst_sel:DWORD dst_unused:UNUSED_PAD src0_sel:WORD_1 src1_sel:WORD_0
    s_mov_b32 m0, s93
    s_nop 0
    buffer_load_dwordx4 v23, s[44:47], s90 offen lds
    s_add_u32 m0, s93, 1024
    s_nop 0
    buffer_load_dwordx4 v23, s[44:47], s89 offen lds
    s_mov_b64 vcc, s[72:73]
    s_lshr_b32 s63, s91, 16
    s_lshl_b32 s63, s63, 10
    v_cndmask_b32_sdwa v24, v81, v80, vcc dst_sel:DWORD dst_unused:UNUSED_PAD src0_sel:WORD_0 src1_sel:WORD_1
    s_and_b32 s62, s91, 0xffff
    s_lshl_b32 s62, s62, 10
    v_mul_u32_u24 v71, 1171, v0
    s_lshl_b32 s70, s52, 7
    v_add_u32 v24, s93, v24
    v_add_u32_sdwa v27, s70, v82 dst_sel:DWORD dst_unused:UNUSED_PAD src0_sel:DWORD src1_sel:WORD_1
    s_mul_i32 s70, s52, 960
    v_lshrrev_b32 v71, 16, v71
    v_add_u32 v26, s70, v1
    s_mul_i32 s70, s2, 896
    s_lshl_b32 s71, s52, 10
    v_mul_u32_u24 v71, 228480, v71
    s_add_u32 s70, s70, s71
    s_add_u32 s64, s70, 10485760
    v_add_u32 v71, v71, v1
    s_waitcnt vmcnt(9)
    v_lshlrev_b32_sdwa v12, 4, v78 dst_sel:DWORD dst_unused:UNUSED_PAD src0_sel:DWORD src1_sel:WORD_1
    s_mov_b32 s48, s30
    s_mov_b32 s49, s31
    s_cmp_eq_u32 s52, 7
    s_cselect_b32 s50, 0, 67108864
    s_mov_b32 s51, 0x20000
    s_mul_i32 s76, s52, 229376
    s_lshl_b32 s68, s55, 7
    s_add_u32 s76, s76, s68
    s_add_u32 s76, s76, 12582912
    s_lshr_b32 s68, s54, 2
    s_lshl3_add_u32 s57, s53, s68
    s_and_b32 s58, s54, 3
    s_lshr_b32 s59, s57, 1
    s_and_b32 s60, s54, 7
    s_mul_i32 s82, s58, 7
    s_add_u32 s82, s82, s52
    s_mul_i32 s84, s82, 14336
    s_add_u32 s85, s84, 401408
    s_mul_i32 s86, s60, 7
    s_add_u32 s86, s86, s52
    s_mul_i32 s87, s86, 28672
    s_add_u32 s86, s87, 802816
    s_add_u32 s87, s87, 2408448
    s_lshl3_add_u32 s74, s53, s52
    s_mul_i32 s74, s74, 28672
    s_lshl_b32 s68, s54, 5
    s_add_u32 s74, s74, s68
    s_add_u32 s74, s74, 10485760
    s_lshl_b32 s65, s52, 11
    s_add_u32 s65, s65, 6291456
    s_mov_b32 s61, 0
    s_and_b32 s68, s43, 6
    s_cmp_eq_u32 s68, 2
    s_cselect_b32 s46, 1605632, 0
    s_cselect_b32 s67, 67108864, 0
    v_mov_b32 v51, 0x3f803f80
    s_waitcnt vmcnt(6)
    v_dot2_f32_bf16 v48, v28, v51, 0
    v_dot2_f32_bf16 v49, v28, v28, 0
    v_dot2_f32_bf16 v48, v29, v51, v48
    v_dot2_f32_bf16 v49, v29, v29, v49
    v_dot2_f32_bf16 v48, v30, v51, v48
    v_dot2_f32_bf16 v49, v30, v30, v49
    v_dot2_f32_bf16 v48, v31, v51, v48
    v_dot2_f32_bf16 v49, v31, v31, v49
    v_and_b32 v39, 0xffff0000, v31
    v_lshlrev_b32 v38, 16, v31
    v_mov_b32 v50, 991054117
    v_add_f32_dpp v48, v48, v48 row_shr:1
    v_add_f32_dpp v49, v49, v49 row_shr:1
    v_and_b32 v37, 0xffff0000, v30
    v_add_f32_dpp v48, v48, v48 row_shr:2
    v_add_f32_dpp v49, v49, v49 row_shr:2
    v_lshlrev_b32 v36, 16, v30
    v_add_f32_dpp v48, v48, v48 row_shr:4
    v_add_f32_dpp v49, v49, v49 row_shr:4
    v_and_b32 v35, 0xffff0000, v29
    v_add_f32_dpp v48, v48, v48 row_shr:8
    v_add_f32_dpp v49, v49, v49 row_shr:8
    v_lshlrev_b32 v34, 16, v29
    v_add_f32_dpp v48, v48, v48 row_bcast:15 row_mask:0xa
    v_add_f32_dpp v49, v49, v49 row_bcast:15 row_mask:0xa
    v_and_b32 v33, 0xffff0000, v28
    v_add_f32_dpp v48, v48, v48 row_bcast:31 row_mask:0xc
    v_add_f32_dpp v49, v49, v49 row_bcast:31 row_mask:0xc
    v_lshlrev_b32 v32, 16, v28
    v_readlane_b32 s70, v48, 63
    v_readlane_b32 s71, v49, 63
    s_lshl_b32 s72, s52, 3
    v_mov_b32 v65, s72
    v_mul_f32 v49, s70, v50
    v_mul_f32 v48, s71, v50
    v_fma_f32 v48, -v49, v49, v48
    v_max_f32 v48, 0, v48
    v_add_f32 v48, 925353388, v48
    v_rsq_f32 v51, v48
    s_mov_b32 exec_hi, 0x00ffffff
    v_mul_f32 v50, -v49, v51
    v_pk_fma_f32 v[40:41], v[50:51], v[32:33], v[50:51] op_sel:[1,0,0] op_sel_hi:[1,1,0]
    v_pk_fma_f32 v[42:43], v[50:51], v[34:35], v[50:51] op_sel:[1,0,0] op_sel_hi:[1,1,0]
    v_pk_fma_f32 v[44:45], v[50:51], v[36:37], v[50:51] op_sel:[1,0,0] op_sel_hi:[1,1,0]
    v_pk_fma_f32 v[46:47], v[50:51], v[38:39], v[50:51] op_sel:[1,0,0] op_sel_hi:[1,1,0]
    s_mov_b32 s70, 0x0d800000
    v_pk_mul_f32 v[40:41], v[40:41], s[70:71] op_sel_hi:[1,0]
    v_pk_mul_f32 v[42:43], v[42:43], s[70:71] op_sel_hi:[1,0]
    v_pk_mul_f32 v[44:45], v[44:45], s[70:71] op_sel_hi:[1,0]
    v_pk_mul_f32 v[46:47], v[46:47], s[70:71] op_sel_hi:[1,0]
    v_cvt_pk_bf16_f32 v28, v40, v41
    v_cvt_pk_bf16_f32 v29, v42, v43
    v_cvt_pk_bf16_f32 v30, v44, v45
    v_cvt_pk_bf16_f32 v31, v46, v47
    ds_write_b128 v26, v[28:31] offset:0
    v_mul_f32 v48, v48, v51
    s_mov_b64 exec, 1
    ds_write_b64 v65, v[48:49] offset:7680
    s_mov_b64 exec, -1
    s_waitcnt lgkmcnt(0)
    s_barrier
    ds_read_b64_tr_b16 v[48:49], v27 offset:0
    ds_read_b64_tr_b16 v[50:51], v27 offset:3840
    s_lshr_b32 s56, s56, 4
    s_mul_i32 s56, s56, 1664525
    s_add_u32 s56, s56, 1013904223
    s_lshl_b32 s56, s56, 4
    s_and_b32 s78, s56, 0x70000000
    s_or_b32 s78, s78, 0x6000
    s_lshl_b32 s79, s56, 3
    s_and_b32 s79, s79, 0x70000000
    s_or_b32 s79, s79, 0x1000
    s_lshl_b32 s80, s56, 8
    s_and_b32 s80, s80, 0x70007000
    s_lshl_b32 s81, s56, 5
    s_and_b32 s81, s81, 0x70007000
    v_mov_b32 v46, 0x8fff8ffe
    v_mov_b32 v47, 0x8fff8fff
    s_waitcnt lgkmcnt(1)
    v_and_or_b32 v48, v48, v46, s78
    v_and_or_b32 v49, v49, v47, s79
    s_waitcnt lgkmcnt(0)
    v_and_or_b32 v50, v50, v47, s80
    v_and_or_b32 v51, v51, v47, s81
    s_cmp_lg_u32 s52, 7
    s_cbranch_scc1 Lc2
    s_mov_b64 exec, 15
    ds_read_b128 v[48:51], v1 offset:7680
    v_mov_b32 v71, v1
    s_lshl_b32 s64, s2, 6
    s_add_u32 s64, s64, 6291456
    s_waitcnt lgkmcnt(0)
Lc2:
    buffer_store_dwordx4 v[48:51], v71, s[32:35], s64 offen sc1
    s_mov_b64 exec, -1
    s_getreg_b32 s70, hwreg(HW_REG_XCC_ID, 0, 4)
    s_add_u32 s83, s70, s56
    s_waitcnt vmcnt(3)
    s_cmp_ge_u32 s43, 2
    s_cbranch_scc1 Lc3
    s_waitcnt vmcnt(1)
    ds_read_b64_tr_b16 v[52:53], v24
    ds_read_b64_tr_b16 v[54:55], v24 offset:256
    ds_read_b64_tr_b16 v[56:57], v24 offset:32
    ds_read_b64_tr_b16 v[58:59], v24 offset:288
    s_waitcnt lgkmcnt(2)
    buffer_store_dwordx4 v[52:55], v1, s[32:35], s62 offen sc1
    s_waitcnt lgkmcnt(0)
    buffer_store_dwordx4 v[56:59], v1, s[32:35], s63 offen sc1
    s_nop 1
Lc3:
    s_cmp_ge_u32 s54, 28
    s_cbranch_scc1 Lnonconv
    v_mov_b32 v72, -1
    v_mov_b32 v73, -1
    v_mov_b32 v74, -1
    v_mov_b32 v75, -1
    buffer_store_dwordx4 v[72:75], v12, s[32:35], s76 offen sc1
    s_lshl_b32 s71, s52, 10
    s_lshl4_add_u32 s66, s2, 33751040
    s_add_u32 s77, s71, 111104
    v_add_u32 v13, s71, v1
    s_lshl_b32 s70, s52, 13
    v_add_u32 v14, s70, v1
    s_lshl_b32 s70, s52, 9
    s_mul_i32 s72, s53, 4352
    s_add_u32 s70, s70, s72
    s_add_u32 s70, s70, 33751040
    v_and_b32 v17, 0x1f0, v1
    v_add_u32 v17, s70, v17
    s_mul_i32 s75, s52, 4608
    s_add_u32 s75, s75, 31744
    v_add_u32_sdwa v20, s75, v80 dst_sel:DWORD dst_unused:UNUSED_PAD src0_sel:DWORD src1_sel:WORD_0
    v_mov_b32_sdwa v10, v77 dst_sel:DWORD dst_unused:UNUSED_PAD src0_sel:WORD_1
    v_mov_b32_sdwa v11, v78 dst_sel:DWORD dst_unused:UNUSED_PAD src0_sel:WORD_0
    v_add_u32_sdwa v15, s77, v79 dst_sel:DWORD dst_unused:UNUSED_PAD src0_sel:DWORD src1_sel:WORD_0
    s_and_b32 s70, s52, 3
    s_lshr_b32 s71, s52, 2
    s_mul_i32 s73, s71, 8320
    s_add_u32 s73, s73, 93312
    v_add_u32 v18, s73, v18
    s_lshl_b32 s72, s70, 7
    s_sub_u32 s72, s73, s72
    s_add_u32 s72, s72, 3456
    v_add_u32_sdwa v4, s72, v76 dst_sel:DWORD dst_unused:UNUSED_PAD src0_sel:DWORD src1_sel:WORD_0
    s_lshl_b32 s72, s70, 8
    s_sub_u32 s72, 110080, s72
    v_xor_b32 v16, 16, v15
    v_add_u32_sdwa v8, s72, v76 dst_sel:DWORD dst_unused:UNUSED_PAD src0_sel:DWORD src1_sel:WORD_1
    v_add_u32_sdwa v9, s72, v77 dst_sel:DWORD dst_unused:UNUSED_PAD src0_sel:DWORD src1_sel:WORD_0
    s_xor_b32 s72, s70, s71
    s_and_b32 s72, s72, 1
    s_lshl_b32 s72, s72, 4
    v_subrev_u32 v5, 1024, v4
    v_subrev_u32 v6, 2048, v4
    v_subrev_u32 v7, 3072, v4
    v_xor_b32 v8, s72, v8
    v_xor_b32 v9, s72, v9
    s_lshl_b32 s72, s70, 2
    s_mul_i32 s70, s71, 12320
    s_add_u32 s70, s70, 68608
    s_mov_b32 s73, 97408
    v_xor_b32_sdwa v19, s72, v79 dst_sel:DWORD dst_unused:UNUSED_PAD src0_sel:DWORD src1_sel:WORD_1
    v_add_u32_sdwa v88, s73, v83 dst_sel:DWORD dst_unused:UNUSED_PAD src0_sel:DWORD src1_sel:WORD_0
    v_mov_b32 v84, 0
    v_mov_b32 v85, 0
    v_mov_b32 v86, 0
    v_mov_b32 v87, 0
    v_add_u32 v19, s70, v19
    s_add_u32 s72, s70, 12288
    s_bitcmp1_b32 s52, 0
    s_cselect_b64 vcc, -1, 0
    v_add_u32 v89, 110080, v1
    v_writelane_b32 v88, s72, 63
    v_cndmask_b32 v88, v89, v88, vcc
    ds_write_b128 v88, v[84:87]
    v_add_u32_sdwa v132, s70, v66 dst_sel:DWORD dst_unused:UNUSED_PAD src0_sel:DWORD src1_sel:WORD_0
    v_add_u32_sdwa v133, s70, v66 dst_sel:DWORD dst_unused:UNUSED_PAD src0_sel:DWORD src1_sel:WORD_1
    v_add_u32_sdwa v134, s70, v67 dst_sel:DWORD dst_unused:UNUSED_PAD src0_sel:DWORD src1_sel:WORD_0
    v_add_u32_sdwa v135, s70, v67 dst_sel:DWORD dst_unused:UNUSED_PAD src0_sel:DWORD src1_sel:WORD_1
    v_add_u32_sdwa v136, s70, v68 dst_sel:DWORD dst_unused:UNUSED_PAD src0_sel:DWORD src1_sel:WORD_0
    v_add_u32_sdwa v137, s70, v68 dst_sel:DWORD dst_unused:UNUSED_PAD src0_sel:DWORD src1_sel:WORD_1
    v_add_u32_sdwa v138, s70, v69 dst_sel:DWORD dst_unused:UNUSED_PAD src0_sel:DWORD src1_sel:WORD_0
    v_add_u32_sdwa v139, s70, v69 dst_sel:DWORD dst_unused:UNUSED_PAD src0_sel:DWORD src1_sel:WORD_1
    v_add_u32_sdwa v140, s70, v70 dst_sel:DWORD dst_unused:UNUSED_PAD src0_sel:DWORD src1_sel:WORD_0
    s_lshl_b32 s70, s40, 16
    s_and_b32 s71, s40, 0xffff0000
    s_cmp_lt_u32 s52, 4
    s_cselect_b32 s72, s70, s71
    s_mov_b32 s70, 1069066811
    s_mov_b32 s71, 1042479491
    v_mov_b32 v64, s72
    v_lshlrev_b32 v60, 16, v60
    v_mul_f32 v64, s70, v64
    v_mul_f32 v60, s70, v60
    v_exp_f32 v64, v64
    v_exp_f32 v60, v60
    v_lshlrev_b32 v61, 16, v61
    v_lshlrev_b32 v62, 16, v62
    v_lshlrev_b32 v63, 16, v63
    v_cvt_pk_bf16_f32 v64, v64, v60
    v_and_b32 v60, 0xffff0000, v64
    v_lshlrev_b32 v64, 16, v64
    v_pk_mul_f32 v[60:61], v[60:61], v[64:65] op_sel_hi:[1,0]
    v_add_f32 v64, v64, v64
    v_pk_mul_f32 v[60:61], v[60:61], s[70:71]
    v_pk_mul_f32 v[112:113], v[62:63], v[64:65] op_sel_hi:[1,0]
    s_mov_b32 m0, s75
    s_mov_b32 s70, 0x41000000
    s_mov_b32 s71, 0x43000000
    v_pk_mul_f32 v[62:63], v[60:61], s[70:71] op_sel_hi:[1,0]
    v_pk_mul_f32 v[64:65], s[70:71], v[60:61] op_sel:[1,0]
    s_lshl_b32 s41, s42, 16
    s_and_b32 s42, s42, 0xffff0000
    v_exp_f32 v62, -v62
    v_fract_f32 v63, v63
    v_exp_f32 v64, -v64
    v_fract_f32 v65, v65
    v_exp_f32 v60, -v60
    v_fract_f32 v61, v61
    v_cos_f32 v90, v63
    v_sin_f32 v91, v63
    v_cos_f32 v92, v65
    v_sin_f32 v93, v65
    v_cos_f32 v76, v61
    v_sin_f32 v77, v61
    v_pk_mul_f32 v[90:91], v[90:91], v[62:63] op_sel_hi:[1,0]
    v_pk_mul_f32 v[92:93], v[92:93], v[64:65] op_sel_hi:[1,0]
    v_pk_mul_f32 v[76:77], v[76:77], v[60:61] op_sel_hi:[1,0]
    v_pk_mul_f32 v[100:101], v[112:113], v[90:91] op_sel_hi:[1,0]
    v_cvt_pk_bf16_f32 v102, v112, -v113
    v_pk_fma_f32 v[96:97], v[112:113], v[90:91], v[100:101] op_sel:[1,1,0] op_sel_hi:[0,1,1] neg_lo:[1,0,0]
    ds_write_addtid_b32 v102 offset:0
    v_pk_mul_f32 v[100:101], v[96:97], v[90:91] op_sel_hi:[1,0]
    v_cvt_pk_bf16_f32 v103, v96, -v97
    v_pk_fma_f32 v[98:99], v[96:97], v[90:91], v[100:101] op_sel:[1,1,0] op_sel_hi:[0,1,1] neg_lo:[1,0,0]
    ds_write_addtid_b32 v103 offset:288
    v_pk_mul_f32 v[100:101], v[98:99], v[90:91] op_sel_hi:[1,0]
    v_cvt_pk_bf16_f32 v102, v98, -v99
    v_pk_fma_f32 v[96:97], v[98:99], v[90:91], v[100:101] op_sel:[1,1,0] op_sel_hi:[0,1,1] neg_lo:[1,0,0]
    ds_write_addtid_b32 v102 offset:576
    v_pk_mul_f32 v[100:101], v[96:97], v[90:91] op_sel_hi:[1,0]
    v_cvt_pk_bf16_f32 v103, v96, -v97
    v_pk_fma_f32 v[98:99], v[96:97], v[90:91], v[100:101] op_sel:[1,1,0] op_sel_hi:[0,1,1] neg_lo:[1,0,0]
    ds_write_addtid_b32 v103 offset:864
    v_pk_mul_f32 v[100:101], v[98:99], v[90:91] op_sel_hi:[1,0]
    v_cvt_pk_bf16_f32 v102, v98, -v99
    v_pk_fma_f32 v[96:97], v[98:99], v[90:91], v[100:101] op_sel:[1,1,0] op_sel_hi:[0,1,1] neg_lo:[1,0,0]
    ds_write_addtid_b32 v102 offset:1152
    v_pk_mul_f32 v[100:101], v[96:97], v[90:91] op_sel_hi:[1,0]
    v_cvt_pk_bf16_f32 v103, v96, -v97
    v_pk_fma_f32 v[98:99], v[96:97], v[90:91], v[100:101] op_sel:[1,1,0] op_sel_hi:[0,1,1] neg_lo:[1,0,0]
    ds_write_addtid_b32 v103 offset:1440
    v_pk_mul_f32 v[100:101], v[98:99], v[90:91] op_sel_hi:[1,0]
    v_cvt_pk_bf16_f32 v102, v98, -v99
    v_pk_fma_f32 v[96:97], v[98:99], v[90:91], v[100:101] op_sel:[1,1,0] op_sel_hi:[0,1,1] neg_lo:[1,0,0]
    ds_write_addtid_b32 v102 offset:1728
    v_pk_mul_f32 v[100:101], v[96:97], v[90:91] op_sel_hi:[1,0]
    v_cvt_pk_bf16_f32 v103, v96, -v97
    v_pk_fma_f32 v[98:99], v[96:97], v[90:91], v[100:101] op_sel:[1,1,0] op_sel_hi:[0,1,1] neg_lo:[1,0,0]
    ds_write_addtid_b32 v103 offset:2016
    v_pk_mul_f32 v[100:101], v[98:99], v[90:91] op_sel_hi:[1,0]
    v_cvt_pk_bf16_f32 v102, v98, -v99
    v_pk_fma_f32 v[96:97], v[98:99], v[90:91], v[100:101] op_sel:[1,1,0] op_sel_hi:[0,1,1] neg_lo:[1,0,0]
    ds_write_addtid_b32 v102 offset:2304
    v_pk_mul_f32 v[100:101], v[96:97], v[90:91] op_sel_hi:[1,0]
    v_cvt_pk_bf16_f32 v103, v96, -v97
    v_pk_fma_f32 v[98:99], v[96:97], v[90:91], v[100:101] op_sel:[1,1,0] op_sel_hi:[0,1,1] neg_lo:[1,0,0]
    ds_write_addtid_b32 v103 offset:2592
    v_pk_mul_f32 v[100:101], v[98:99], v[90:91] op_sel_hi:[1,0]
    v_cvt_pk_bf16_f32 v102, v98, -v99
    v_pk_fma_f32 v[96:97], v[98:99], v[90:91], v[100:101] op_sel:[1,1,0] op_sel_hi:[0,1,1] neg_lo:[1,0,0]
    ds_write_addtid_b32 v102 offset:2880
    v_pk_mul_f32 v[100:101], v[96:97], v[90:91] op_sel_hi:[1,0]
    v_cvt_pk_bf16_f32 v103, v96, -v97
    v_pk_fma_f32 v[98:99], v[96:97], v[90:91], v[100:101] op_sel:[1,1,0] op_sel_hi:[0,1,1] neg_lo:[1,0,0]
    ds_write_addtid_b32 v103 offset:3168
    v_pk_mul_f32 v[100:101], v[98:99], v[90:91] op_sel_hi:[1,0]
    v_cvt_pk_bf16_f32 v102, v98, -v99
    v_pk_fma_f32 v[96:97], v[98:99], v[90:91], v[100:101] op_sel:[1,1,0] op_sel_hi:[0,1,1] neg_lo:[1,0,0]
    ds_write_addtid_b32 v102 offset:3456
    v_pk_mul_f32 v[100:101], v[96:97], v[90:91] op_sel_hi:[1,0]
    v_cvt_pk_bf16_f32 v103, v96, -v97
    v_pk_fma_f32 v[98:99], v[96:97], v[90:91], v[100:101] op_sel:[1,1,0] op_sel_hi:[0,1,1] neg_lo:[1,0,0]
    ds_write_addtid_b32 v103 offset:3744
    v_pk_mul_f32 v[100:101], v[98:99], v[90:91] op_sel_hi:[1,0]
    v_cvt_pk_bf16_f32 v102, v98, -v99
    v_pk_fma_f32 v[96:97], v[98:99], v[90:91], v[100:101] op_sel:[1,1,0] op_sel_hi:[0,1,1] neg_lo:[1,0,0]
    ds_write_addtid_b32 v102 offset:4032
    v_cvt_pk_bf16_f32 v103, v96, -v97
    ds_write_addtid_b32 v103 offset:4320
    ds_read_b128 v[156:159], v20 offset:0
    ds_read_b128 v[160:163], v20 offset:64
    ds_read_b128 v[164:167], v20 offset:128
    ds_read_b128 v[168:171], v20 offset:192
    v_pk_mul_f32 v[116:117], v[76:77], v[76:77] op_sel_hi:[1,0]
    v_pk_fma_f32 v[78:79], v[76:77], v[76:77], v[116:117] op_sel:[1,1,0] op_sel_hi:[0,1,1] neg_lo:[1,0,0]
    v_pk_mul_f32 v[116:117], v[78:79], v[78:79] op_sel_hi:[1,0]
    v_pk_fma_f32 v[82:83], v[78:79], v[78:79], v[116:117] op_sel:[1,1,0] op_sel_hi:[0,1,1] neg_lo:[1,0,0]
    s_waitcnt vmcnt(0)
    s_barrier
    s_cmp_lg_u32 s52, 0
    s_cbranch_scc1 Lc4
    v_mov_b32 v118, s83
    v_mul_u32_u24 v119, 4352, v2
    s_mov_b64 exec, 0xff
    buffer_store_dword v118, v119, s[32:35], s66 offen sc1
    s_mov_b64 exec, -1
Lc4:
    s_lshl4_add_u32 s66, s2, 33816576
    v_pk_mul_f32 v[100:101], v[90:91], v[92:93] op_sel_hi:[1,0]
    v_cvt_pk_bf16_f32 v102, v90, v91
    v_pk_fma_f32 v[96:97], v[90:91], v[92:93], v[100:101] op_sel:[1,1,0] op_sel_hi:[0,1,1] neg_lo:[1,0,0]
    ds_write_addtid_b32 v102 offset:0
    v_pk_mul_f32 v[100:101], v[96:97], v[92:93] op_sel_hi:[1,0]
    v_cvt_pk_bf16_f32 v103, v96, v97
    v_pk_fma_f32 v[98:99], v[96:97], v[92:93], v[100:101] op_sel:[1,1,0] op_sel_hi:[0,1,1] neg_lo:[1,0,0]
    ds_write_addtid_b32 v103 offset:288
    v_pk_mul_f32 v[100:101], v[98:99], v[92:93] op_sel_hi:[1,0]
    v_cvt_pk_bf16_f32 v102, v98, v99
    v_pk_fma_f32 v[96:97], v[98:99], v[92:93], v[100:101] op_sel:[1,1,0] op_sel_hi:[0,1,1] neg_lo:[1,0,0]
    ds_write_addtid_b32 v102 offset:576
    v_pk_mul_f32 v[100:101], v[96:97], v[92:93] op_sel_hi:[1,0]
    v_cvt_pk_bf16_f32 v103, v96, v97
    v_pk_fma_f32 v[98:99], v[96:97], v[92:93], v[100:101] op_sel:[1,1,0] op_sel_hi:[0,1,1] neg_lo:[1,0,0]
    ds_write_addtid_b32 v103 offset:864
    v_pk_mul_f32 v[100:101], v[98:99], v[92:93] op_sel_hi:[1,0]
    v_cvt_pk_bf16_f32 v102, v98, v99
    v_pk_fma_f32 v[96:97], v[98:99], v[92:93], v[100:101] op_sel:[1,1,0] op_sel_hi:[0,1,1] neg_lo:[1,0,0]
    ds_write_addtid_b32 v102 offset:1152
    v_pk_mul_f32 v[100:101], v[96:97], v[92:93] op_sel_hi:[1,0]
    v_cvt_pk_bf16_f32 v103, v96, v97
    v_pk_fma_f32 v[98:99], v[96:97], v[92:93], v[100:101] op_sel:[1,1,0] op_sel_hi:[0,1,1] neg_lo:[1,0,0]
    ds_write_addtid_b32 v103 offset:1440
    v_pk_mul_f32 v[100:101], v[98:99], v[92:93] op_sel_hi:[1,0]
    v_cvt_pk_bf16_f32 v102, v98, v99
    v_pk_fma_f32 v[96:97], v[98:99], v[92:93], v[100:101] op_sel:[1,1,0] op_sel_hi:[0,1,1] neg_lo:[1,0,0]
    ds_write_addtid_b32 v102 offset:1728
    v_pk_mul_f32 v[100:101], v[96:97], v[92:93] op_sel_hi:[1,0]
    v_cvt_pk_bf16_f32 v103, v96, v97
    v_pk_fma_f32 v[98:99], v[96:97], v[92:93], v[100:101] op_sel:[1,1,0] op_sel_hi:[0,1,1] neg_lo:[1,0,0]
    ds_write_addtid_b32 v103 offset:2016
    v_pk_mul_f32 v[100:101], v[98:99], v[92:93] op_sel_hi:[1,0]
    v_cvt_pk_bf16_f32 v102, v98, v99
    v_pk_fma_f32 v[96:97], v[98:99], v[92:93], v[100:101] op_sel:[1,1,0] op_sel_hi:[0,1,1] neg_lo:[1,0,0]
    ds_write_addtid_b32 v102 offset:2304
    v_pk_mul_f32 v[100:101], v[96:97], v[92:93] op_sel_hi:[1,0]
    v_cvt_pk_bf16_f32 v103, v96, v97
    v_pk_fma_f32 v[98:99], v[96:97], v[92:93], v[100:101] op_sel:[1,1,0] op_sel_hi:[0,1,1] neg_lo:[1,0,0]
    ds_write_addtid_b32 v103 offset:2592
    v_pk_mul_f32 v[100:101], v[98:99], v[92:93] op_sel_hi:[1,0]
    v_cvt_pk_bf16_f32 v102, v98, v99
    v_pk_fma_f32 v[96:97], v[98:99], v[92:93], v[100:101] op_sel:[1,1,0] op_sel_hi:[0,1,1] neg_lo:[1,0,0]
    ds_write_addtid_b32 v102 offset:2880
    v_pk_mul_f32 v[100:101], v[96:97], v[92:93] op_sel_hi:[1,0]
    v_cvt_pk_bf16_f32 v103, v96, v97
    v_pk_fma_f32 v[98:99], v[96:97], v[92:93], v[100:101] op_sel:[1,1,0] op_sel_hi:[0,1,1] neg_lo:[1,0,0]
    ds_write_addtid_b32 v103 offset:3168
    v_pk_mul_f32 v[100:101], v[98:99], v[92:93] op_sel_hi:[1,0]
    v_cvt_pk_bf16_f32 v102, v98, v99
    v_pk_fma_f32 v[96:97], v[98:99], v[92:93], v[100:101] op_sel:[1,1,0] op_sel_hi:[0,1,1] neg_lo:[1,0,0]
    ds_write_addtid_b32 v102 offset:3456
    v_pk_mul_f32 v[100:101], v[96:97], v[92:93] op_sel_hi:[1,0]
    v_cvt_pk_bf16_f32 v103, v96, v97
    v_pk_fma_f32 v[98:99], v[96:97], v[92:93], v[100:101] op_sel:[1,1,0] op_sel_hi:[0,1,1] neg_lo:[1,0,0]
    ds_write_addtid_b32 v103 offset:3744
    v_pk_mul_f32 v[100:101], v[98:99], v[92:93] op_sel_hi:[1,0]
    v_cvt_pk_bf16_f32 v102, v98, v99
    v_pk_fma_f32 v[96:97], v[98:99], v[92:93], v[100:101] op_sel:[1,1,0] op_sel_hi:[0,1,1] neg_lo:[1,0,0]
    ds_write_addtid_b32 v102 offset:4032
    v_cvt_pk_bf16_f32 v103, v96, v97
    ds_write_addtid_b32 v103 offset:4320
    ds_read_b128 v[172:175], v20 offset:0
    ds_read_b128 v[176:179], v20 offset:64
    ds_read_b128 v[180:183], v20 offset:128
    ds_read_b128 v[184:187], v20 offset:192
    v_pk_mul_f32 v[100:101], v[82:83], v[78:79] op_sel_hi:[1,0]
    v_pk_mul_f32 v[108:109], v[78:79], v[76:77] op_sel_hi:[1,0]
    v_pk_mul_f32 v[116:117], v[82:83], v[76:77] op_sel_hi:[1,0]
    v_pk_fma_f32 v[86:87], v[82:83], v[78:79], v[100:101] op_sel:[1,1,0] op_sel_hi:[0,1,1] neg_lo:[1,0,0]
    v_pk_fma_f32 v[80:81], v[78:79], v[76:77], v[108:109] op_sel:[1,1,0] op_sel_hi:[0,1,1] neg_lo:[1,0,0]
    v_pk_fma_f32 v[84:85], v[82:83], v[76:77], v[116:117] op_sel:[1,1,0] op_sel_hi:[0,1,1] neg_lo:[1,0,0]
    buffer_load_dwordx4 v[120:123], v10, s[32:35], s74 offen sc1
    v_pk_mul_f32 v[100:101], v[82:83], v[92:93] op_sel_hi:[1,0]
    v_cvt_pk_bf16_f32 v102, v82, v83
    v_pk_fma_f32 v[96:97], v[82:83], v[92:93], v[100:101] op_sel:[1,1,0] op_sel_hi:[0,1,1] neg_lo:[1,0,0]
    ds_write_addtid_b32 v102 offset:0
    v_pk_mul_f32 v[100:101], v[96:97], v[92:93] op_sel_hi:[1,0]
    v_cvt_pk_bf16_f32 v103, v96, v97
    v_pk_fma_f32 v[98:99], v[96:97], v[92:93], v[100:101] op_sel:[1,1,0] op_sel_hi:[0,1,1] neg_lo:[1,0,0]
    ds_write_addtid_b32 v103 offset:288
    v_pk_mul_f32 v[100:101], v[98:99], v[92:93] op_sel_hi:[1,0]
    v_cvt_pk_bf16_f32 v102, v98, v99
    v_pk_fma_f32 v[96:97], v[98:99], v[92:93], v[100:101] op_sel:[1,1,0] op_sel_hi:[0,1,1] neg_lo:[1,0,0]
    ds_write_addtid_b32 v102 offset:576
    v_pk_mul_f32 v[100:101], v[96:97], v[92:93] op_sel_hi:[1,0]
    v_cvt_pk_bf16_f32 v103, v96, v97
    v_pk_fma_f32 v[98:99], v[96:97], v[92:93], v[100:101] op_sel:[1,1,0] op_sel_hi:[0,1,1] neg_lo:[1,0,0]
    ds_write_addtid_b32 v103 offset:864
    v_pk_mul_f32 v[100:101], v[98:99], v[92:93] op_sel_hi:[1,0]
    v_cvt_pk_bf16_f32 v102, v98, v99
    v_pk_fma_f32 v[96:97], v[98:99], v[92:93], v[100:101] op_sel:[1,1,0] op_sel_hi:[0,1,1] neg_lo:[1,0,0]
    ds_write_addtid_b32 v102 offset:1152
    v_pk_mul_f32 v[100:101], v[96:97], v[92:93] op_sel_hi:[1,0]
    v_cvt_pk_bf16_f32 v103, v96, v97
    v_pk_fma_f32 v[98:99], v[96:97], v[92:93], v[100:101] op_sel:[1,1,0] op_sel_hi:[0,1,1] neg_lo:[1,0,0]
    ds_write_addtid_b32 v103 offset:1440
    v_pk_mul_f32 v[100:101], v[98:99], v[92:93] op_sel_hi:[1,0]
    v_cvt_pk_bf16_f32 v102, v98, v99
    v_pk_fma_f32 v[96:97], v[98:99], v[92:93], v[100:101] op_sel:[1,1,0] op_sel_hi:[0,1,1] neg_lo:[1,0,0]
    ds_write_addtid_b32 v102 offset:1728
    v_cvt_pk_bf16_f32 v103, v96, v97
    ds_write_addtid_b32 v103 offset:2016
    v_pk_mul_f32 v[108:109], v[78:79], v[92:93] op_sel_hi:[1,0]
    v_cvt_pk_bf16_f32 v110, v78, v79
    v_pk_fma_f32 v[104:105], v[78:79], v[92:93], v[108:109] op_sel:[1,1,0] op_sel_hi:[0,1,1] neg_lo:[1,0,0]
    ds_write_addtid_b32 v110 offset:2304
    v_pk_mul_f32 v[108:109], v[104:105], v[92:93] op_sel_hi:[1,0]
    v_cvt_pk_bf16_f32 v111, v104, v105
    v_pk_fma_f32 v[106:107], v[104:105], v[92:93], v[108:109] op_sel:[1,1,0] op_sel_hi:[0,1,1] neg_lo:[1,0,0]
    ds_write_addtid_b32 v111 offset:2592
    v_pk_mul_f32 v[108:109], v[106:107], v[92:93] op_sel_hi:[1,0]
    v_cvt_pk_bf16_f32 v110, v106, v107
    v_pk_fma_f32 v[104:105], v[106:107], v[92:93], v[108:109] op_sel:[1,1,0] op_sel_hi:[0,1,1] neg_lo:[1,0,0]
    ds_write_addtid_b32 v110 offset:2880
    v_cvt_pk_bf16_f32 v111, v104, v105
    ds_write_addtid_b32 v111 offset:3168
    v_pk_mul_f32 v[108:109], v[86:87], v[92:93] op_sel_hi:[1,0]
    v_cvt_pk_bf16_f32 v110, v86, v87
    v_pk_fma_f32 v[104:105], v[86:87], v[92:93], v[108:109] op_sel:[1,1,0] op_sel_hi:[0,1,1] neg_lo:[1,0,0]
    ds_write_addtid_b32 v110 offset:3456
    v_pk_mul_f32 v[108:109], v[104:105], v[92:93] op_sel_hi:[1,0]
    v_cvt_pk_bf16_f32 v111, v104, v105
    v_pk_fma_f32 v[106:107], v[104:105], v[92:93], v[108:109] op_sel:[1,1,0] op_sel_hi:[0,1,1] neg_lo:[1,0,0]
    ds_write_addtid_b32 v111 offset:3744
    v_pk_mul_f32 v[108:109], v[106:107], v[92:93] op_sel_hi:[1,0]
    v_cvt_pk_bf16_f32 v110, v106, v107
    v_pk_fma_f32 v[104:105], v[106:107], v[92:93], v[108:109] op_sel:[1,1,0] op_sel_hi:[0,1,1] neg_lo:[1,0,0]
    ds_write_addtid_b32 v110 offset:4032
    v_cvt_pk_bf16_f32 v111, v104, v105
    ds_write_addtid_b32 v111 offset:4320
    v_pk_mul_f32 v[116:117], v[86:87], v[76:77] op_sel_hi:[1,0]
    v_pk_fma_f32 v[88:89], v[86:87], v[76:77], v[116:117] op_sel:[1,1,0] op_sel_hi:[0,1,1] neg_lo:[1,0,0]
    ds_read_b128 v[188:191], v20 offset:0
    ds_read_b128 v[192:195], v20 offset:64
    ds_read_b128 v[196:199], v20 offset:128
    ds_read_b128 v[200:203], v20 offset:192
    s_waitcnt lgkmcnt(15)
    v_mfma_f32_16x16x32_bf16 v[220:223], v[172:175], v[156:159], 0
    v_mov_b32 v116, 0x3f80
    ds_write_addtid_b32 v116 offset:2304
    v_cvt_pk_bf16_f32 v98, v76, v77
    v_mul_f32 v96, v76, v92
    v_mfma_f32_16x16x32_bf16 v[220:223], v[176:179], v[160:163], v[220:223]
    ds_write_addtid_b32 v98 offset:0
    v_mul_f32 v97, v77, v92
    v_fma_f32 v96, -v77, v93, v96
    v_fmac_f32 v97, v76, v93
    v_mfma_f32_16x16x32_bf16 v[220:223], v[180:183], v[164:167], v[220:223]
    v_cvt_pk_bf16_f32 v99, v96, v97
    ds_write_addtid_b32 v99 offset:288
    v_cvt_pk_bf16_f32 v102, v80, v81
    v_mul_f32 v100, v80, v92
    v_mfma_f32_16x16x32_bf16 v[220:223], v[184:187], v[168:171], v[220:223]
    ds_write_addtid_b32 v102 offset:576
    v_mul_f32 v101, v81, v92
    v_fma_f32 v100, -v81, v93, v100
    v_fmac_f32 v101, v80, v93
    s_waitcnt lgkmcnt(7)
    v_mfma_f32_16x16x32_bf16 v[224:227], v[188:191], v[156:159], 0
    v_cvt_pk_bf16_f32 v103, v100, v101
    ds_write_addtid_b32 v103 offset:864
    v_cvt_pk_bf16_f32 v106, v84, v85
    v_mul_f32 v104, v84, v92
    s_waitcnt lgkmcnt(7)
    v_mfma_f32_16x16x32_bf16 v[224:227], v[192:195], v[160:163], v[224:227]
    ds_write_addtid_b32 v106 offset:1152
    v_mul_f32 v105, v85, v92
    v_fma_f32 v104, -v85, v93, v104
    v_fmac_f32 v105, v84, v93
    s_waitcnt lgkmcnt(7)
    v_mfma_f32_16x16x32_bf16 v[224:227], v[196:199], v[164:167], v[224:227]
    v_cvt_pk_bf16_f32 v107, v104, v105
    ds_write_addtid_b32 v107 offset:1440
    v_cvt_pk_bf16_f32 v110, v88, v89
    v_mul_f32 v108, v88, v92
    s_waitcnt lgkmcnt(7)
    v_mfma_f32_16x16x32_bf16 v[224:227], v[200:203], v[168:171], v[224:227]
    ds_write_addtid_b32 v110 offset:1728
    v_mul_f32 v109, v89, v92
    v_fma_f32 v108, -v89, v93, v108
    v_fmac_f32 v109, v88, v93
    v_cvt_pk_bf16_f32 v111, v108, v109
    ds_write_addtid_b32 v111 offset:2016
    ds_read_b128 v[204:207], v20 offset:0
    ds_read_b128 v[208:211], v20 offset:64
    ds_read_b128 v[212:215], v20 offset:128
    ds_read_b128 v[216:219], v20 offset:192
    buffer_load_dword v27, v17, s[32:35], 0 offen sc1
    ds_write_b32 v19, v220 offset:0
    ds_write_b32 v19, v221 offset:256
    ds_write_b32 v19, v222 offset:512
    ds_write_b32 v19, v223 offset:768
    s_waitcnt lgkmcnt(7)
    v_mfma_f32_16x16x32_bf16 v[228:231], v[204:207], v[156:159], 0
    ds_write_b32 v19, v224 offset:4096
    s_waitcnt lgkmcnt(7)
    v_mfma_f32_16x16x32_bf16 v[228:231], v[208:211], v[160:163], v[228:231]
    ds_write_b32 v19, v225 offset:4352
    s_waitcnt lgkmcnt(7)
    v_mfma_f32_16x16x32_bf16 v[228:231], v[212:215], v[164:167], v[228:231]
    ds_write_b32 v19, v226 offset:4608
    s_waitcnt lgkmcnt(7)
    v_mfma_f32_16x16x32_bf16 v[228:231], v[216:219], v[168:171], v[228:231]
    ds_write_b32 v19, v227 offset:4864
    s_nop 6
    ds_write_b32 v19, v228 offset:8192
    ds_write_b32 v19, v229 offset:8448
    ds_write_b32 v19, v230 offset:8704
    ds_write_b32 v19, v231 offset:8960
    s_mov_b32 m0, s93
    s_nop 0
    buffer_load_dwordx4 v23, s[44:47], s90 offen lds
    s_add_u32 m0, s93, 1024
    s_nop 0
    buffer_load_dwordx4 v23, s[44:47], s89 offen lds
    s_waitcnt lgkmcnt(0)
    s_barrier
    ds_read_b128 v[28:31], v132
    ds_read_b128 v[32:35], v133
    ds_read_b128 v[36:39], v134
    ds_read_b128 v[40:43], v135
    ds_read_b128 v[44:47], v136
    ds_read_b128 v[48:51], v137
    ds_read_b128 v[52:55], v138
    ds_read_b128 v[56:59], v139
    ds_read_b128 v[60:63], v140
    s_waitcnt lgkmcnt(8)
    v_pk_add_f32 v[28:29], v[28:29], v[30:31]
    s_waitcnt lgkmcnt(7)
    v_pk_add_f32 v[32:33], v[32:33], v[34:35]
    v_add_f32 v28, v28, v29
    s_waitcnt lgkmcnt(6)
    v_pk_add_f32 v[36:37], v[36:37], v[38:39]
    v_add_f32 v32, v32, v33
    s_waitcnt lgkmcnt(5)
    v_pk_add_f32 v[40:41], v[40:41], v[42:43]
    v_add_f32 v36, v36, v37
    s_waitcnt lgkmcnt(4)
    v_pk_add_f32 v[44:45], v[44:45], v[46:47]
    v_add_f32 v40, v40, v41
    s_waitcnt lgkmcnt(3)
    v_pk_add_f32 v[48:49], v[48:49], v[50:51]
    v_add_f32 v44, v44, v45
    s_waitcnt lgkmcnt(2)
    v_pk_add_f32 v[52:53], v[52:53], v[54:55]
    v_add_f32 v48, v48, v49
    s_waitcnt lgkmcnt(1)
    v_pk_add_f32 v[56:57], v[56:57], v[58:59]
    v_add_f32 v52, v52, v53
    s_waitcnt lgkmcnt(0)
    v_pk_add_f32 v[60:61], v[60:61], v[62:63]
    v_add_f32 v56, v56, v57
    v_add_f32 v60, v60, v61
    v_cvt_pk_bf16_f32 v64, v28, v32
    v_cvt_pk_bf16_f32 v65, v36, v40
    v_cvt_pk_bf16_f32 v66, v44, v48
    v_cvt_pk_bf16_f32 v67, v52, v56
    ds_write_b128 v18, v[64:67]
    v_cvt_pk_bf16_f32 v68, v32, v36
    v_cvt_pk_bf16_f32 v69, v40, v44
    v_cvt_pk_bf16_f32 v70, v48, v52
    v_cvt_pk_bf16_f32 v71, v56, v60
    ds_write_b128 v18, v[68:71] offset:4160
    s_waitcnt vmcnt(3)
    v_xor_b32 v120, s78, v120
    v_xor_b32 v121, s79, v121
    v_xor_b32 v122, s80, v122
    v_xor_b32 v123, s81, v123
    v_or3_b32 v119, v120, v121, v122
    v_or_b32 v119, v119, v123
    v_and_b32 v119, 0x70007000, v119
    v_cmp_ne_u32 vcc, 0, v119
    s_mov_b32 s97, 0
    s_nop 0
    s_cbranch_vccnz Lur5
Lub6:
    v_add_u32 v120, 0x32003200, v120
    v_add_u32 v121, 0x32003200, v121
    v_add_u32 v122, 0x32003200, v122
    v_add_u32 v123, 0x32003200, v123
    v_add_u32 v119, s77, v1
    ds_write_b128 v119, v[120:123]
    s_waitcnt vmcnt(2)
    v_subrev_u32 v27, s56, v27
    v_cmp_lt_u32 vcc, 15, v27
    s_mov_b32 s97, 0
    s_nop 0
    s_cbranch_vccnz Lpr7
Lpb8:
    s_waitcnt lgkmcnt(0)
    s_barrier
    ds_read2_b32 v[28:29], v4 offset0:144 offset1:145
    ds_read2_b32 v[30:31], v4 offset0:146 offset1:147
    ds_read_b128 v[60:63], v8 offset:0
    ds_read2_b32 v[32:33], v4 offset0:16 offset1:17
    ds_read2_b32 v[34:35], v4 offset0:18 offset1:19
    ds_read_b128 v[64:67], v8 offset:1024
    ds_read2_b32 v[36:37], v5 offset0:144 offset1:145
    ds_read2_b32 v[38:39], v5 offset0:146 offset1:147
    ds_read_b128 v[68:71], v8 offset:2048
    s_waitcnt lgkmcnt(6)
    v_mfma_f32_16x16x32_bf16 v[92:95], v[28:31], v[60:63], 0
    ds_read2_b32 v[40:41], v5 offset0:16 offset1:17
    s_waitcnt lgkmcnt(5)
    v_mfma_f32_16x16x32_bf16 v[96:99], v[32:35], v[60:63], 0
    ds_read2_b32 v[42:43], v5 offset0:18 offset1:19
    buffer_load_dwordx4 v[124:127], v11, s[32:35], s65 offen sc1
    s_waitcnt lgkmcnt(5)
    v_mfma_f32_16x16x32_bf16 v[100:103], v[32:35], v[64:67], 0
    ds_read_b128 v[72:75], v8 offset:3072
    buffer_load_dwordx4 v[128:131], v11, s[32:35], s65 offen offset:16 sc1
    s_lshl_b32 s68, s2, 6
    s_add_u32 s68, s68, 33660928
    v_mfma_f32_16x16x32_bf16 v[96:99], v[28:31], v[64:67], v[96:99]
    ds_read2_b32 v[44:45], v6 offset0:144 offset1:145
    buffer_load_dwordx4 v[144:147], v1, s[48:51], s84 offen offset:0
    s_waitcnt lgkmcnt(5)
    v_mfma_f32_16x16x32_bf16 v[100:103], v[36:39], v[60:63], v[100:103]
    ds_read2_b32 v[46:47], v6 offset0:146 offset1:147
    v_lshrrev_b32 v19, 3, v0
    v_mfma_f32_16x16x32_bf16 v[104:107], v[36:39], v[64:67], 0
    ds_read_b128 v[76:79], v8 offset:4096
    v_and_b32 v20, 7, v0
    s_waitcnt lgkmcnt(6)
    v_mfma_f32_16x16x32_bf16 v[108:111], v[36:39], v[68:71], 0
    ds_read2_b32 v[48:49], v6 offset0:16 offset1:17
    v_lshlrev_b32 v21, 9, v19
    v_mfma_f32_16x16x32_bf16 v[100:103], v[28:31], v[68:71], v[100:103]
    ds_read2_b32 v[50:51], v6 offset0:18 offset1:19
    buffer_load_dwordx4 v[148:151], v1, s[48:51], s84 offen offset:1024
    v_lshl_add_u32 v21, v20, 4, v21
    v_mfma_f32_16x16x32_bf16 v[104:107], v[32:35], v[68:71], v[104:107]
    ds_read_b128 v[80:83], v8 offset:5120
    s_andn2_b32 s70, 1, s58
    s_waitcnt lgkmcnt(7)
    v_mfma_f32_16x16x32_bf16 v[104:107], v[40:43], v[60:63], v[104:107]
    ds_read2_b32 v[52:53], v7 offset0:144 offset1:145
    v_add_u32 v20, s70, v20
    v_mfma_f32_16x16x32_bf16 v[108:111], v[40:43], v[64:67], v[108:111]
    ds_read2_b32 v[54:55], v7 offset0:146 offset1:147
    v_mul_u32_u24 v22, 768, v19
    v_mfma_f32_16x16x32_bf16 v[112:115], v[40:43], v[68:71], 0
    ds_read_b128 v[84:87], v8 offset:6144
    buffer_load_dwordx4 v[152:155], v1, s[48:51], s84 offen offset:2048
    v_lshrrev_b32 v18, 2, v20
    s_waitcnt lgkmcnt(9)
    v_mfma_f32_16x16x32_bf16 v[116:119], v[40:43], v[72:75], 0
    ds_read2_b32 v[56:57], v7 offset0:16 offset1:17
    v_lshl_add_u32 v22, v18, 8, v22
    v_mfma_f32_16x16x32_bf16 v[104:107], v[28:31], v[72:75], v[104:107]
    ds_read2_b32 v[58:59], v7 offset0:18 offset1:19
    v_and_b32 v18, 3, v20
    v_mfma_f32_16x16x32_bf16 v[108:111], v[32:35], v[72:75], v[108:111]
    ds_read_b128 v[88:91], v8 offset:7168
    v_lshl_add_u32 v22, v18, 4, v22
    v_mfma_f32_16x16x32_bf16 v[112:115], v[36:39], v[72:75], v[112:115]
    buffer_load_dwordx4 v[156:159], v1, s[48:51], s84 offen offset:3072
    v_add_u32 v22, 106880, v22
    s_waitcnt lgkmcnt(10)
    v_mfma_f32_16x16x32_bf16 v[108:111], v[44:47], v[60:63], v[108:111]
    s_mul_i32 s88, s57, 28672
    v_mfma_f32_16x16x32_bf16 v[112:115], v[44:47], v[64:67], v[112:115]
    s_add_u32 s88, s88, 12582912
    v_mfma_f32_16x16x32_bf16 v[116:119], v[44:47], v[68:71], v[116:119]
    v_add_u32 v26, 65536, v17
    v_mfma_f32_16x16x32_bf16 v[120:123], v[44:47], v[72:75], 0
    ds_read2_b32 v[44:45], v4 offset0:128 offset1:129
    s_add_u32 s84, s84, 4096
    buffer_load_dwordx4 v[160:163], v1, s[48:51], s84 offen offset:0
    s_waitcnt lgkmcnt(10)
    v_mfma_f32_16x16x32_bf16 v[108:111], v[28:31], v[76:79], v[108:111]
    ds_read2_b32 v[46:47], v4 offset0:130 offset1:131
    v_mfma_f32_16x16x32_bf16 v[112:115], v[32:35], v[76:79], v[112:115]
    v_mfma_f32_16x16x32_bf16 v[116:119], v[36:39], v[76:79], v[116:119]
    v_mfma_f32_16x16x32_bf16 v[120:123], v[40:43], v[76:79], v[120:123]
    ds_read_b128 v[76:79], v9 offset:0
    s_waitcnt lgkmcnt(10)
    v_mfma_f32_16x16x32_bf16 v[112:115], v[48:51], v[60:63], v[112:115]
    ds_read_b128 v[72:75], v9 offset:1024
    s_waitcnt vmcnt(7)
    ds_read_b64_tr_b16 v[240:241], v24 offset:0
    ds_read_b64_tr_b16 v[242:243], v24 offset:256
    ds_read_b64_tr_b16 v[244:245], v24 offset:1024
    ds_read_b64_tr_b16 v[246:247], v24 offset:1280
    s_cmp_lg_u32 s43, 2
    s_nop 0
    s_cbranch_scc1 Lc9
    s_mov_b32 vcc_lo, 0xf0f00f0f
    s_mov_b32 vcc_hi, 0xf0f00f0f
    v_mov_b32 v252, 0x3f803f80
    v_cndmask_b32 v248, 0, v252, vcc
    v_cndmask_b32 v249, 0, v252, vcc
    v_cndmask_b32 v250, 0, v252, vcc
    v_cndmask_b32 v251, 0, v252, vcc
    s_lshr_b32 s72, s62, 4
    s_add_u32 s72, s72, 7289856
    s_waitcnt lgkmcnt(2)
    v_mfma_f32_16x16x32_bf16 v[252:255], v[248:251], v[240:243], 0
    s_waitcnt lgkmcnt(0)
    v_mfma_f32_16x16x32_bf16 v[252:255], v[248:251], v[244:247], v[252:255]
    v_lshlrev_b32 v248, 2, v2
    s_mov_b32 exec_hi, 0
    s_nop 5
    buffer_store_dword v252, v248, s[32:35], s72 offen sc1
    s_mov_b32 exec_hi, -1
Lc9:
    s_mov_b32 s44, s30
    s_mov_b32 s45, s31
    s_mov_b32 s46, s67
    s_waitcnt lgkmcnt(2)
    buffer_store_dwordx4 v[240:243], v1, s[44:47], s62 offen sc1
    s_waitcnt lgkmcnt(0)
    buffer_store_dwordx4 v[244:247], v1, s[44:47], s63 offen sc1
    buffer_load_dwordx4 v[164:167], v1, s[48:51], s84 offen offset:1024
    v_mfma_f32_16x16x32_bf16 v[116:119], v[48:51], v[64:67], v[116:119]
    ds_read2_b32 v[40:41], v4 offset0:0 offset1:1
    v_mfma_f32_16x16x32_bf16 v[120:123], v[48:51], v[68:71], v[120:123]
    ds_read2_b32 v[42:43], v4 offset0:2 offset1:3
    v_mfma_f32_16x16x32_bf16 v[112:115], v[28:31], v[80:83], v[112:115]
    v_mfma_f32_16x16x32_bf16 v[116:119], v[32:35], v[80:83], v[116:119]
    buffer_load_dwordx4 v[168:171], v1, s[48:51], s84 offen offset:2048
    v_mfma_f32_16x16x32_bf16 v[120:123], v[36:39], v[80:83], v[120:123]
    ds_read_b128 v[80:83], v9 offset:2048
    v_mfma_f32_16x16x32_bf16 v[116:119], v[52:55], v[60:63], v[116:119]
    ds_read2_b32 v[48:49], v5 offset0:128 offset1:129
    v_mfma_f32_16x16x32_bf16 v[120:123], v[52:55], v[64:67], v[120:123]
    ds_read2_b32 v[50:51], v5 offset0:130 offset1:131
    v_mfma_f32_16x16x32_bf16 v[116:119], v[28:31], v[84:87], v[116:119]
    ds_read_b128 v[68:71], v9 offset:3072
    buffer_load_dwordx4 v[172:175], v1, s[48:51], s84 offen offset:3072
    v_mfma_f32_16x16x32_bf16 v[120:123], v[32:35], v[84:87], v[120:123]
    ds_read2_b32 v[36:37], v5 offset0:0 offset1:1
    v_mfma_f32_16x16x32_bf16 v[120:123], v[56:59], v[60:63], v[120:123]
    ds_read2_b32 v[38:39], v5 offset0:2 offset1:3
    v_mfma_f32_16x16x32_bf16 v[120:123], v[28:31], v[88:91], v[120:123]
    ds_read_b128 v[84:87], v9 offset:4096
    v_mfma_f32_16x16x32_bf16 v[92:95], v[44:47], v[76:79], v[92:95]
    ds_read2_b32 v[52:53], v6 offset0:128 offset1:129
    s_add_u32 s84, s84, 4096
    buffer_load_dwordx4 v[176:179], v1, s[48:51], s84 offen offset:0
    v_mfma_f32_16x16x32_bf16 v[96:99], v[44:47], v[72:75], v[96:99]
    ds_read2_b32 v[54:55], v6 offset0:130 offset1:131
    s_waitcnt lgkmcnt(9)
    v_mfma_f32_16x16x32_bf16 v[96:99], v[40:43], v[76:79], v[96:99]
    ds_read_b128 v[64:67], v9 offset:5120
    s_waitcnt lgkmcnt(9)
    v_mfma_f32_16x16x32_bf16 v[100:103], v[44:47], v[80:83], v[100:103]
    ds_read2_b32 v[32:33], v6 offset0:0 offset1:1
    v_mfma_f32_16x16x32_bf16 v[100:103], v[40:43], v[72:75], v[100:103]
    ds_read2_b32 v[34:35], v6 offset0:2 offset1:3
    buffer_load_dwordx4 v[180:183], v1, s[48:51], s84 offen offset:1024
    ds_read_b64 v[140:141], v15
    s_waitcnt lgkmcnt(10)
    v_mfma_f32_16x16x32_bf16 v[100:103], v[48:51], v[76:79], v[100:103]
    ds_read_b128 v[88:91], v9 offset:6144
    ds_read_b64 v[142:143], v16
    s_waitcnt lgkmcnt(11)
    v_mfma_f32_16x16x32_bf16 v[104:107], v[44:47], v[68:71], v[104:107]
    ds_read2_b32 v[56:57], v7 offset0:128 offset1:129
    ds_write_b128 v13, v[92:95] offset:0
    v_mfma_f32_16x16x32_bf16 v[104:107], v[40:43], v[80:83], v[104:107]
    ds_read2_b32 v[58:59], v7 offset0:130 offset1:131
    v_mfma_f32_16x16x32_bf16 v[104:107], v[48:51], v[72:75], v[104:107]
    ds_read_b128 v[60:63], v9 offset:7168
    s_waitcnt lgkmcnt(13)
    v_mfma_f32_16x16x32_bf16 v[104:107], v[36:39], v[76:79], v[104:107]
    ds_read2_b32 v[28:29], v7 offset0:0 offset1:1
    buffer_load_dwordx4 v[184:187], v1, s[48:51], s84 offen offset:2048
    s_waitcnt lgkmcnt(13)
    v_mfma_f32_16x16x32_bf16 v[108:111], v[44:47], v[84:87], v[108:111]
    ds_read2_b32 v[30:31], v7 offset0:2 offset1:3
    ds_write_b128 v13, v[96:99] offset:8192
    s_waitcnt lgkmcnt(9)
    v_lshlrev_b32 v132, 16, v140
    v_mfma_f32_16x16x32_bf16 v[108:111], v[40:43], v[68:71], v[108:111]
    v_and_b32 v133, 0xffff0000, v140
    v_mfma_f32_16x16x32_bf16 v[108:111], v[48:51], v[80:83], v[108:111]
    v_lshlrev_b32 v134, 16, v141
    v_mfma_f32_16x16x32_bf16 v[108:111], v[36:39], v[72:75], v[108:111]
    buffer_load_dwordx4 v[188:191], v1, s[48:51], s84 offen offset:3072
    v_and_b32 v135, 0xffff0000, v141
    v_mfma_f32_16x16x32_bf16 v[108:111], v[52:55], v[76:79], v[108:111]
    ds_write_b128 v13, v[100:103] offset:16384
    s_waitcnt lgkmcnt(8)
    v_lshlrev_b32 v136, 16, v142
    v_mfma_f32_16x16x32_bf16 v[112:115], v[44:47], v[64:67], v[112:115]
    v_and_b32 v137, 0xffff0000, v142
    v_mfma_f32_16x16x32_bf16 v[112:115], v[40:43], v[84:87], v[112:115]
    v_lshlrev_b32 v138, 16, v143
    v_mfma_f32_16x16x32_bf16 v[112:115], v[48:51], v[68:71], v[112:115]
    s_add_u32 s84, s84, 4096
    buffer_load_dwordx4 v[192:195], v1, s[48:51], s84 offen offset:0
    v_and_b32 v139, 0xffff0000, v143
    v_mfma_f32_16x16x32_bf16 v[112:115], v[36:39], v[80:83], v[112:115]
    ds_write_b128 v13, v[104:107] offset:24576
    s_waitcnt vmcnt(16)
    v_add_f32 v140, s41, v124
    v_mfma_f32_16x16x32_bf16 v[112:115], v[52:55], v[72:75], v[112:115]
    v_add_f32 v141, s41, v126
    v_mfma_f32_16x16x32_bf16 v[112:115], v[32:35], v[76:79], v[112:115]
    s_waitcnt vmcnt(15)
    v_add_f32 v142, s41, v128
    v_mfma_f32_16x16x32_bf16 v[116:119], v[44:47], v[88:91], v[116:119]
    buffer_load_dwordx4 v[196:199], v1, s[48:51], s84 offen offset:1024
    v_add_f32 v143, s41, v130
    v_mfma_f32_16x16x32_bf16 v[116:119], v[40:43], v[64:67], v[116:119]
    ds_write_b128 v13, v[108:111] offset:32768
    v_fma_f32 v132, v132, v140, v125
    v_mfma_f32_16x16x32_bf16 v[116:119], v[48:51], v[84:87], v[116:119]
    v_fma_f32 v133, v133, v141, v127
    v_mfma_f32_16x16x32_bf16 v[116:119], v[36:39], v[68:71], v[116:119]
    v_fma_f32 v134, v134, v142, v129
    v_mfma_f32_16x16x32_bf16 v[116:119], v[52:55], v[80:83], v[116:119]
    buffer_load_dwordx4 v[200:203], v1, s[48:51], s85 offen offset:0
    v_fma_f32 v135, v135, v143, v131
    v_mfma_f32_16x16x32_bf16 v[116:119], v[32:35], v[72:75], v[116:119]
    ds_write_b128 v13, v[112:115] offset:40960
    v_add_f32 v140, s42, v124
    s_waitcnt lgkmcnt(8)
    v_mfma_f32_16x16x32_bf16 v[116:119], v[56:59], v[76:79], v[116:119]
    v_add_f32 v141, s42, v126
    s_waitcnt lgkmcnt(7)
    v_mfma_f32_16x16x32_bf16 v[120:123], v[44:47], v[60:63], v[120:123]
    v_add_f32 v142, s42, v128
    v_mfma_f32_16x16x32_bf16 v[120:123], v[40:43], v[88:91], v[120:123]
    v_add_f32 v143, s42, v130
    v_mfma_f32_16x16x32_bf16 v[120:123], v[48:51], v[64:67], v[120:123]
    s_nop 0
    ds_write_b128 v13, v[116:119] offset:49152
    v_fma_f32 v136, v136, v140, v125
    v_mfma_f32_16x16x32_bf16 v[120:123], v[36:39], v[84:87], v[120:123]
    v_fma_f32 v137, v137, v141, v127
    v_mfma_f32_16x16x32_bf16 v[120:123], v[52:55], v[68:71], v[120:123]
    v_fma_f32 v138, v138, v142, v129
    v_mfma_f32_16x16x32_bf16 v[120:123], v[32:35], v[80:83], v[120:123]
    v_fma_f32 v139, v139, v143, v131
    v_mfma_f32_16x16x32_bf16 v[120:123], v[56:59], v[72:75], v[120:123]
    s_waitcnt lgkmcnt(6)
    v_mfma_f32_16x16x32_bf16 v[120:123], v[28:31], v[76:79], v[120:123]
    s_nop 7
    ds_write_b128 v13, v[120:123] offset:57344
    s_waitcnt vmcnt(10)
    s_waitcnt lgkmcnt(0)
    s_barrier
    ds_read_b128 v[28:31], v14 offset:0
    ds_read_b128 v[44:47], v14 offset:4096
    ds_read_b128 v[32:35], v14 offset:1024
    ds_read_b128 v[48:51], v14 offset:5120
    ds_read_b128 v[36:39], v14 offset:2048
    ds_read_b128 v[52:55], v14 offset:6144
    ds_read_b128 v[40:43], v14 offset:3072
    ds_read_b128 v[56:59], v14 offset:7168
    s_cmp_lg_u32 s52, 6
    s_cbranch_scc1 Lc10
    v_mov_b32 v23, s56
    v_mul_u32_u24 v24, 4352, v2
    s_mov_b64 exec, 0xff
    buffer_store_dword v23, v24, s[32:35], s66 offen sc1
    s_mov_b64 exec, -1
Lc10:
    s_cmp_lg_u32 s52, 7
    s_cbranch_scc1 Lc11
    v_mov_b32 v17, s56
    s_mov_b64 exec, 1
    buffer_store_dword v17, off, s[32:35], s68 sc1
    s_mov_b64 exec, -1
Lc11:
    s_waitcnt lgkmcnt(7)
    v_pk_add_f32 v[132:133], v[132:133], v[28:29]
    v_pk_add_f32 v[134:135], v[134:135], v[30:31]
    s_waitcnt lgkmcnt(6)
    v_pk_add_f32 v[136:137], v[136:137], v[44:45]
    v_pk_add_f32 v[138:139], v[138:139], v[46:47]
    s_waitcnt lgkmcnt(5)
    v_pk_add_f32 v[132:133], v[132:133], v[32:33]
    v_pk_add_f32 v[134:135], v[134:135], v[34:35]
    s_waitcnt lgkmcnt(4)
    v_pk_add_f32 v[136:137], v[136:137], v[48:49]
    v_pk_add_f32 v[138:139], v[138:139], v[50:51]
    s_waitcnt lgkmcnt(3)
    v_pk_add_f32 v[132:133], v[132:133], v[36:37]
    v_pk_add_f32 v[134:135], v[134:135], v[38:39]
    s_waitcnt lgkmcnt(2)
    v_pk_add_f32 v[136:137], v[136:137], v[52:53]
    v_pk_add_f32 v[138:139], v[138:139], v[54:55]
    s_waitcnt lgkmcnt(1)
    v_pk_add_f32 v[132:133], v[132:133], v[40:41]
    v_pk_add_f32 v[134:135], v[134:135], v[42:43]
    s_waitcnt lgkmcnt(0)
    v_pk_add_f32 v[136:137], v[136:137], v[56:57]
    v_pk_add_f32 v[138:139], v[138:139], v[58:59]
    v_cvt_pk_bf16_f32 v140, v132, v136
    v_cvt_pk_bf16_f32 v141, v133, v137
    v_cvt_pk_bf16_f32 v142, v134, v138
    v_cvt_pk_bf16_f32 v143, v135, v139
    v_and_b32 v140, -2, v140
    buffer_store_dwordx4 v[140:143], v12, s[32:35], s76 offen sc1
Ljoin:
    v_mov_b32 v4, v21
    v_mov_b32 v5, v22
    s_cmp_eq_u32 s52, 7
    s_nop 0
    s_cbranch_scc1 Lsw
    s_lshl_b32 s70, s58, 2
    s_lshr_b32 s71, 0x2213, s70
    s_and_b32 s71, s71, 15
    s_lshr_b32 s72, 0x0404, s70
    s_and_b32 s72, s72, 15
    v_and_b32 v44, 15, v2
    v_lshrrev_b32 v45, 4, v2
    v_add_u32 v46, s71, v44
    v_add_u32 v47, s72, v44
    v_and_b32 v48, 3, v46
    v_lshlrev_b32 v48, 2, v48
    v_and_or_b32 v48, v46, -16, v48
    v_bfe_u32 v6, v46, 2, 2
    v_or_b32 v6, v6, v48
    v_lshlrev_b32 v6, 4, v6
    v_mul_u32_u24 v48, 768, v45
    v_add_u32 v6, v6, v48
    v_add_u32 v6, 106880, v6
    v_and_b32 v48, 3, v47
    v_lshlrev_b32 v48, 2, v48
    v_and_or_b32 v48, v47, -16, v48
    v_bfe_u32 v7, v47, 2, 2
    v_or_b32 v7, v7, v48
    v_lshlrev_b32 v7, 4, v7
    v_lshrrev_b32 v48, 1, v45
    s_lshl_b32 s73, s82, 1
    v_add_u32 v48, s73, v48
    v_mul_u32_u24 v48, 768, v48
    v_and_b32 v49, 1, v45
    v_lshl_add_u32 v48, v49, 3, v48
    v_add_u32 v7, v7, v48
    v_add_u32 v7, 106880, v7
    s_sub_u32 s73, s71, s72
    s_lshl_b32 s70, s57, 5
    s_add_u32 s73, s73, s70
    v_add_u32 v48, s73, v44
    v_add_u32 v49, 16, v48
    s_movk_i32 s70, 2048
    v_cmp_gt_u32 s[78:79], s70, v48
    v_cmp_gt_u32 s[80:81], s70, v49
    v_lshlrev_b32 v50, 4, v46
    v_add_u32 v50, 149888, v50
    v_lshlrev_b32 v51, 3, v47
    v_add_u32 v51, 150656, v51
    s_add_u32 s70, s58, 1
    s_and_b32 s70, s70, 3
    s_mul_i32 s70, s70, 7
    s_add_u32 s70, s70, s52
    s_lshl_b32 s4, s70, 10
    s_add_u32 s70, s58, 2
    s_and_b32 s70, s70, 3
    s_mul_i32 s70, s70, 7
    s_add_u32 s70, s70, s52
    s_lshl_b32 s5, s70, 10
    s_add_u32 s70, s58, 3
    s_and_b32 s70, s70, 3
    s_mul_i32 s70, s70, 7
    s_add_u32 s70, s70, s52
    s_lshl_b32 s6, s70, 10
    s_lshl_b32 s7, s52, 10
    s_mul_i32 s8, s57, 28672
    s_add_u32 s8, s8, 10485760
    s_xor_b32 s9, s57, 1
    s_mul_i32 s9, s9, 28672
    s_add_u32 s9, s9, s7
    s_add_u32 s9, s9, 12582912
    s_lshl_b32 s69, s82, 10
    s_add_u32 s70, s69, s8
    s_add_u32 s71, s70, 2097152
    v_add_u32 v46, s69, v1
    v_add_u32 v47, s7, v1
    v_mov_b32 v28, 0x3f803f80
    v_mov_b32 v29, 0x3f803f80
    v_mov_b32 v30, 0x3f803f80
    v_mov_b32 v31, 0x3f803f80
    s_nop 1
    v_mfma_f32_16x16x32_bf16 v[32:35], v[144:147], v[28:31], 0
    v_mfma_f32_16x16x32_bf16 v[32:35], v[148:151], v[28:31], v[32:35]
    v_mfma_f32_16x16x32_bf16 v[32:35], v[152:155], v[28:31], v[32:35]
    v_mfma_f32_16x16x32_bf16 v[32:35], v[156:159], v[28:31], v[32:35]
    v_mfma_f32_16x16x32_bf16 v[32:35], v[160:163], v[28:31], v[32:35]
    s_waitcnt vmcnt(10)
    v_mfma_f32_16x16x32_bf16 v[32:35], v[164:167], v[28:31], v[32:35]
    s_waitcnt vmcnt(9)
    v_mfma_f32_16x16x32_bf16 v[32:35], v[168:171], v[28:31], v[32:35]
    s_waitcnt vmcnt(8)
    v_mfma_f32_16x16x32_bf16 v[32:35], v[172:175], v[28:31], v[32:35]
    s_waitcnt vmcnt(7)
    v_mfma_f32_16x16x32_bf16 v[32:35], v[176:179], v[28:31], v[32:35]
    s_waitcnt vmcnt(6)
    v_mfma_f32_16x16x32_bf16 v[32:35], v[180:183], v[28:31], v[32:35]
    s_waitcnt vmcnt(5)
    v_mfma_f32_16x16x32_bf16 v[32:35], v[184:187], v[28:31], v[32:35]
    s_waitcnt vmcnt(4)
    v_mfma_f32_16x16x32_bf16 v[32:35], v[188:191], v[28:31], v[32:35]
    s_waitcnt vmcnt(3)
    v_mfma_f32_16x16x32_bf16 v[32:35], v[192:195], v[28:31], v[32:35]
    s_waitcnt vmcnt(2)
    v_mfma_f32_16x16x32_bf16 v[32:35], v[196:199], v[28:31], v[32:35]
    s_waitcnt vmcnt(0)
    s_cmp_lt_u32 s54, 28
    s_nop 5
    s_cbranch_scc1 Lc12
    s_lshl_b32 s68, s2, 6
    s_add_u32 s68, s68, 33658880
    v_mov_b32 v9, 0
    s_mov_b32 exec_lo, 1
    s_mov_b32 exec_hi, 0
    buffer_load_dword v8, v9, s[32:35], s68 offen sc1
    s_waitcnt vmcnt(0)
    v_subrev_u32 v8, s56, v8
    v_cmp_lt_u32 vcc, 15, v8
    s_mov_b32 s97, 0
    s_nop 0
    s_cbranch_vccnz Lpr13
Lpb14:
    s_mov_b64 exec, -1
    s_nop 0
Lc12:
    buffer_load_dwordx4 v[8:11], v4, s[32:35], s88 offen offset:0 sc1
    buffer_load_dwordx4 v[12:15], v4, s[32:35], s88 offen offset:128 sc1
    buffer_load_dwordx4 v[16:19], v4, s[32:35], s88 offen offset:256 sc1
    buffer_load_dwordx4 v[20:23], v4, s[32:35], s88 offen offset:384 sc1
    buffer_load_dword v25, v26, s[32:35], 0 offen sc1
    s_waitcnt vmcnt(2)
    v_or3_b32 v24, v8, v12, v16
    s_waitcnt vmcnt(1)
    v_or_b32 v24, v24, v20
    v_and_b32 v24, 1, v24
    v_cmp_eq_u32 vcc, 1, v24
    s_mov_b32 s97, 0
    s_nop 0
    s_cbranch_vccnz Lhr15
Lhb16:
    v_swap_b32 v12, v9
    v_swap_b32 v16, v10
    v_swap_b32 v17, v14
    v_swap_b32 v20, v11
    v_swap_b32 v21, v15
    v_swap_b32 v22, v19
    ds_write_b128 v5, v[8:11] offset:0
    ds_write_b128 v5, v[12:15] offset:64
    ds_write_b128 v5, v[16:19] offset:128
    ds_write_b128 v5, v[20:23] offset:192
    s_waitcnt vmcnt(0)
    v_subrev_u32 v25, s56, v25
    v_cmp_lt_u32 vcc, 15, v25
    s_mov_b32 s97, 0
    s_nop 0
    s_cbranch_vccnz Lpr17
Lpb18:
    buffer_load_dwordx4 v[204:207], v1, s[48:51], s85 offen offset:1024
    buffer_load_dwordx4 v[208:211], v1, s[48:51], s85 offen offset:2048
    buffer_load_dwordx4 v[212:215], v1, s[48:51], s85 offen offset:3072
    s_add_u32 s85, s85, 4096
    buffer_load_dwordx4 v[216:219], v1, s[48:51], s85 offen offset:0
    buffer_load_dwordx4 v[220:223], v1, s[48:51], s85 offen offset:1024
    buffer_load_dwordx4 v[224:227], v1, s[48:51], s85 offen offset:2048
    buffer_load_dwordx4 v[228:231], v1, s[48:51], s85 offen offset:3072
    s_add_u32 s85, s85, 4096
    buffer_load_dwordx4 v[232:235], v1, s[48:51], s85 offen offset:0
    buffer_load_dwordx4 v[236:239], v1, s[48:51], s85 offen offset:1024
    s_waitcnt lgkmcnt(0)
    s_barrier
    v_mov_b32 v4, 151040
    ds_read_b32 v4, v4
    v_lshlrev_b32 v5, 4, v44
    v_lshl_add_u32 v5, v45, 9, v5
    ds_read_b128 v[8:11], v6 offset:0
    ds_read_b128 v[12:15], v6 offset:256
    ds_read_b128 v[16:19], v6 offset:3072
    ds_read_b128 v[20:23], v6 offset:3328
    s_waitcnt lgkmcnt(3)
    v_mfma_f32_16x16x32_bf16 v[24:27], v[144:147], v[8:11], 0
    buffer_load_dwordx4 v[240:243], v1, s[48:51], s85 offen offset:2048
    ds_read_b128 v[8:11], v6 offset:6144
    s_waitcnt lgkmcnt(3)
    v_mfma_f32_16x16x32_bf16 v[28:31], v[144:147], v[12:15], 0
    ds_read_b128 v[12:15], v6 offset:6400
    s_waitcnt lgkmcnt(3)
    v_mfma_f32_16x16x32_bf16 v[24:27], v[148:151], v[16:19], v[24:27]
    buffer_load_dwordx4 v[244:247], v1, s[48:51], s85 offen offset:3072
    ds_read_b128 v[16:19], v6 offset:9216
    s_waitcnt lgkmcnt(3)
    v_mfma_f32_16x16x32_bf16 v[28:31], v[148:151], v[20:23], v[28:31]
    ds_read_b128 v[20:23], v6 offset:9472
    s_waitcnt lgkmcnt(3)
    v_mfma_f32_16x16x32_bf16 v[24:27], v[152:155], v[8:11], v[24:27]
    ds_read_b128 v[8:11], v6 offset:12288
    s_waitcnt lgkmcnt(3)
    v_mfma_f32_16x16x32_bf16 v[28:31], v[152:155], v[12:15], v[28:31]
    s_add_u32 s85, s85, 4096
    buffer_load_dwordx4 v[248:251], v1, s[48:51], s85 offen offset:0
    ds_read_b128 v[12:15], v6 offset:12544
    s_waitcnt lgkmcnt(3)
    v_mfma_f32_16x16x32_bf16 v[24:27], v[156:159], v[16:19], v[24:27]
    ds_read_b128 v[16:19], v6 offset:15360
    s_waitcnt lgkmcnt(3)
    v_mfma_f32_16x16x32_bf16 v[28:31], v[156:159], v[20:23], v[28:31]
    buffer_load_dwordx4 v[252:255], v1, s[48:51], s85 offen offset:1024
    ds_read_b128 v[20:23], v6 offset:15616
    s_waitcnt lgkmcnt(3)
    v_mfma_f32_16x16x32_bf16 v[24:27], v[160:163], v[8:11], v[24:27]
    ds_read_b128 v[8:11], v6 offset:18432
    s_waitcnt lgkmcnt(3)
    v_mfma_f32_16x16x32_bf16 v[28:31], v[160:163], v[12:15], v[28:31]
    ds_read_b128 v[12:15], v6 offset:18688
    s_waitcnt lgkmcnt(3)
    v_mfma_f32_16x16x32_bf16 v[24:27], v[164:167], v[16:19], v[24:27]
    buffer_load_dwordx4 v[52:55], v1, s[48:51], s86 offen offset:0
    ds_read_b128 v[16:19], v6 offset:21504
    s_waitcnt lgkmcnt(3)
    v_mfma_f32_16x16x32_bf16 v[28:31], v[164:167], v[20:23], v[28:31]
    ds_read_b128 v[20:23], v6 offset:21760
    s_waitcnt lgkmcnt(3)
    v_mfma_f32_16x16x32_bf16 v[24:27], v[168:171], v[8:11], v[24:27]
    buffer_load_dwordx4 v[56:59], v1, s[48:51], s86 offen offset:1024
    ds_read_b128 v[8:11], v6 offset:24576
    s_waitcnt lgkmcnt(3)
    v_mfma_f32_16x16x32_bf16 v[28:31], v[168:171], v[12:15], v[28:31]
    ds_read_b128 v[12:15], v6 offset:24832
    s_waitcnt lgkmcnt(3)
    v_mfma_f32_16x16x32_bf16 v[24:27], v[172:175], v[16:19], v[24:27]
    ds_read_b128 v[16:19], v6 offset:27648
    s_waitcnt lgkmcnt(3)
    v_mfma_f32_16x16x32_bf16 v[28:31], v[172:175], v[20:23], v[28:31]
    buffer_load_dwordx4 v[60:63], v1, s[48:51], s86 offen offset:2048
    ds_read_b128 v[20:23], v6 offset:27904
    s_waitcnt lgkmcnt(3)
    v_mfma_f32_16x16x32_bf16 v[24:27], v[176:179], v[8:11], v[24:27]
    ds_read_b128 v[8:11], v6 offset:30720
    s_waitcnt lgkmcnt(3)
    v_mfma_f32_16x16x32_bf16 v[28:31], v[176:179], v[12:15], v[28:31]
    buffer_load_dwordx4 v[64:67], v1, s[48:51], s86 offen offset:3072
    ds_read_b128 v[12:15], v6 offset:30976
    s_waitcnt lgkmcnt(3)
    v_mfma_f32_16x16x32_bf16 v[24:27], v[180:183], v[16:19], v[24:27]
    ds_read_b128 v[16:19], v6 offset:33792
    s_waitcnt lgkmcnt(3)
    v_mfma_f32_16x16x32_bf16 v[28:31], v[180:183], v[20:23], v[28:31]
    ds_read_b128 v[20:23], v6 offset:34048
    s_waitcnt lgkmcnt(3)
    v_mfma_f32_16x16x32_bf16 v[24:27], v[184:187], v[8:11], v[24:27]
    s_add_u32 s86, s86, 4096
    buffer_load_dwordx4 v[68:71], v1, s[48:51], s86 offen offset:0
    ds_read_b128 v[8:11], v6 offset:36864
    s_waitcnt lgkmcnt(3)
    v_mfma_f32_16x16x32_bf16 v[28:31], v[184:187], v[12:15], v[28:31]
    ds_read_b128 v[12:15], v6 offset:37120
    s_waitcnt lgkmcnt(3)
    v_mfma_f32_16x16x32_bf16 v[24:27], v[188:191], v[16:19], v[24:27]
    buffer_load_dwordx4 v[72:75], v1, s[48:51], s86 offen offset:1024
    ds_read_b128 v[16:19], v6 offset:39936
    s_waitcnt lgkmcnt(3)
    v_mfma_f32_16x16x32_bf16 v[28:31], v[188:191], v[20:23], v[28:31]
    ds_read_b128 v[20:23], v6 offset:40192
    s_waitcnt lgkmcnt(3)
    v_mfma_f32_16x16x32_bf16 v[24:27], v[192:195], v[8:11], v[24:27]
    s_waitcnt lgkmcnt(2)
    v_mfma_f32_16x16x32_bf16 v[28:31], v[192:195], v[12:15], v[28:31]
    buffer_load_dwordx4 v[76:79], v1, s[48:51], s86 offen offset:2048
    s_waitcnt lgkmcnt(1)
    v_mfma_f32_16x16x32_bf16 v[24:27], v[196:199], v[16:19], v[24:27]
    s_waitcnt lgkmcnt(0)
    v_mfma_f32_16x16x32_bf16 v[28:31], v[196:199], v[20:23], v[28:31]
    v_readfirstlane_b32 s61, v4
    s_mul_i32 s69, s60, 7
    s_add_u32 s69, s69, s52
    s_mul_i32 s69, s69, 1792
    s_add_u32 s69, s69, 7340032
    v_lshlrev_b32 v48, 2, v2
    v_mov_b32 v4, 100124
    ds_read_b32 v49, v4
    ds_read_b128 v[36:39], v50
    ds_read_b128 v[40:43], v50 offset:256
    s_waitcnt lgkmcnt(2)
    v_cmp_eq_u32 vcc, 0, v49
    s_mov_b32 s97, 0
    s_nop 0
    s_cbranch_vccnz Les19
Leb20:
    s_waitcnt lgkmcnt(1)
    v_fma_f32 v24, -v32, v39, v24
    s_waitcnt lgkmcnt(0)
    v_fma_f32 v28, -v32, v43, v28
    v_fma_f32 v25, -v33, v39, v25
    v_fma_f32 v29, -v33, v43, v29
    v_fma_f32 v26, -v34, v39, v26
    v_fma_f32 v30, -v34, v43, v30
    v_fma_f32 v27, -v35, v39, v27
    v_fma_f32 v31, -v35, v43, v31
    v_mul_f32 v8, v24, v24
    v_mul_f32 v12, v28, v28
    v_mul_f32 v9, v25, v25
    v_mul_f32 v13, v29, v29
    v_mul_f32 v10, v26, v26
    v_mul_f32 v14, v30, v30
    v_mul_f32 v11, v27, v27
    v_mul_f32 v15, v31, v31
    v_fma_f32 v8, v8, v37, v36
    v_fma_f32 v12, v12, v41, v40
    v_fma_f32 v9, v9, v37, v36
    v_fma_f32 v13, v13, v41, v40
    v_fma_f32 v10, v10, v37, v36
    v_fma_f32 v14, v14, v41, v40
    v_fma_f32 v11, v11, v37, v36
    v_fma_f32 v15, v15, v41, v40
    v_mul_f32 v8, v8, v24
    v_mul_f32 v12, v12, v28
    v_mul_f32 v9, v9, v25
    v_mul_f32 v13, v13, v29
    v_mul_f32 v10, v10, v26
    v_mul_f32 v14, v14, v30
    v_mul_f32 v11, v11, v27
    v_mul_f32 v15, v15, v31
    v_exp_f32 v8, v8
    v_exp_f32 v12, v12
    v_exp_f32 v9, v9
    v_exp_f32 v13, v13
    v_exp_f32 v10, v10
    v_exp_f32 v14, v14
    v_exp_f32 v11, v11
    v_exp_f32 v15, v15
    v_fma_f32 v8, v8, v38, v38
    v_fma_f32 v12, v12, v42, v42
    v_fma_f32 v9, v9, v38, v38
    v_fma_f32 v13, v13, v42, v42
    v_fma_f32 v10, v10, v38, v38
    v_fma_f32 v14, v14, v42, v42
    v_fma_f32 v11, v11, v38, v38
    v_fma_f32 v15, v15, v42, v42
    v_rcp_f32 v8, v8
    v_rcp_f32 v12, v12
    v_rcp_f32 v9, v9
    v_rcp_f32 v13, v13
    v_rcp_f32 v10, v10
    v_rcp_f32 v14, v14
    v_rcp_f32 v11, v11
    v_rcp_f32 v15, v15
    v_mul_f32 v8, v8, v24
    v_mul_f32 v12, v12, v28
    v_mul_f32 v9, v9, v25
    v_mul_f32 v13, v13, v29
    v_mul_f32 v10, v10, v26
    v_mul_f32 v14, v14, v30
    v_mul_f32 v11, v11, v27
    v_mul_f32 v15, v15, v31
    v_cvt_pk_bf16_f32 v20, v8, v9
    v_cvt_pk_bf16_f32 v22, v12, v13
    v_cvt_pk_bf16_f32 v21, v10, v11
    v_cvt_pk_bf16_f32 v23, v14, v15
    v_cndmask_b32 v20, 0, v20, s[78:79]
    v_cndmask_b32 v22, 0, v22, s[80:81]
    v_cndmask_b32 v21, 0, v21, s[78:79]
    v_cndmask_b32 v23, 0, v23, s[80:81]
    v_permlane16_swap_b32 v20, v22
    s_nop 0
    v_permlane16_swap_b32 v21, v23
    v_or_b32 v20, 1, v20
    s_cmp_eq_u32 s61, 0
    s_cbranch_scc1 Lxs21
    buffer_store_dwordx4 v[20:23], v1, s[32:35], s70 offen
Lxb22:
    ds_write_b128 v46, v[20:23] offset:0
    ds_read_b64 v[8:9], v7
    ds_read_b64 v[10:11], v7 offset:256
    ds_read_b64 v[12:13], v51
    ds_read_b64 v[14:15], v51 offset:128
    s_waitcnt lgkmcnt(3)
    v_lshlrev_b32 v36, 16, v8
    v_and_b32 v37, 0xffff0000, v8
    v_lshlrev_b32 v38, 16, v9
    v_and_b32 v39, 0xffff0000, v9
    s_waitcnt lgkmcnt(2)
    v_lshlrev_b32 v40, 16, v10
    v_and_b32 v41, 0xffff0000, v10
    v_lshlrev_b32 v42, 16, v11
    v_and_b32 v43, 0xffff0000, v11
    s_waitcnt lgkmcnt(1)
    v_pk_fma_f32 v[24:25], v[12:13], v[36:37], v[12:13] op_sel:[1,0,0] op_sel_hi:[1,1,0]
    v_pk_fma_f32 v[26:27], v[12:13], v[38:39], v[12:13] op_sel:[1,0,0] op_sel_hi:[1,1,0]
    s_waitcnt lgkmcnt(0)
    v_pk_fma_f32 v[28:29], v[14:15], v[40:41], v[14:15] op_sel:[1,0,0] op_sel_hi:[1,1,0]
    v_pk_fma_f32 v[30:31], v[14:15], v[42:43], v[14:15] op_sel:[1,0,0] op_sel_hi:[1,1,0]
    s_waitcnt vmcnt(0)
    s_add_u32 m0, s4, 0
    s_add_u32 s68, s4, s8
    buffer_load_dwordx4 v1, s[32:35], s68 offen sc1 lds
    s_add_u32 m0, s5, 0
    s_add_u32 s68, s5, s8
    buffer_load_dwordx4 v1, s[32:35], s68 offen sc1 lds
    s_add_u32 m0, s6, 0
    s_add_u32 s68, s6, s8
    buffer_load_dwordx4 v1, s[32:35], s68 offen sc1 lds
    v_mov_b32 v34, 0x3f803f80
    v_lshrrev_b32 v35, 1, v47
    v_add_u32 v35, 102400, v35
    s_mul_i32 s70, s52, 260
    s_add_u32 s70, s70, 100352
    v_mov_b32 v45, s70
    s_waitcnt vmcnt(0)
    ds_read_b32 v8, v47 offset:0
    ds_read_b32 v9, v47 offset:7168
    ds_read_b32 v10, v47 offset:14336
    ds_read_b32 v11, v47 offset:21504
    s_waitcnt lgkmcnt(2)
    v_and_b32 v8, v8, v9
    s_waitcnt lgkmcnt(0)
    v_and_b32 v10, v10, v11
    v_and_b32 v8, 1, v8
    v_and_b32 v8, v8, v10
    v_cmp_eq_u32 vcc, 0, v8
    s_mov_b32 s97, 0
    s_nop 0
    s_cbranch_vccnz Lfr23
Lfb24:
    buffer_load_dword v164, v48, s[32:35], s69 offen offset:0
    buffer_load_dword v165, v48, s[32:35], s69 offen offset:256
    buffer_load_dword v166, v48, s[32:35], s69 offen offset:512
    buffer_load_dword v167, v48, s[32:35], s69 offen offset:768
    buffer_load_dword v168, v48, s[32:35], s69 offen offset:1024
    buffer_load_dword v169, v48, s[32:35], s69 offen offset:1280
    buffer_load_dword v170, v48, s[32:35], s69 offen offset:1536
    buffer_load_dwordx4 v[80:83], v1, s[48:51], s86 offen offset:3072
    s_add_u32 s86, s86, 4096
    buffer_load_dwordx4 v[84:87], v1, s[48:51], s86 offen offset:0
    s_add_u32 s8, s8, 2097152
    v_add_u32 v47, 28672, v47
    s_barrier
    ds_read_b128 v[8:11], v5 offset:0
    ds_read_b128 v[12:15], v5 offset:256
    ds_read_b128 v[16:19], v5 offset:2048
    ds_read_b128 v[20:23], v5 offset:2304
    s_waitcnt lgkmcnt(3)
    v_mfma_f32_16x16x32_bf16 v[24:27], v[200:203], v[8:11], v[24:27]
    buffer_load_dwordx4 v[88:91], v1, s[48:51], s86 offen offset:1024
    ds_read_b128 v[8:11], v5 offset:4096
    s_waitcnt lgkmcnt(3)
    v_mfma_f32_16x16x32_bf16 v[28:31], v[200:203], v[12:15], v[28:31]
    ds_read_b128 v[12:15], v5 offset:4352
    s_waitcnt lgkmcnt(3)
    v_mfma_f32_16x16x32_bf16 v[24:27], v[204:207], v[16:19], v[24:27]
    buffer_load_dwordx4 v[92:95], v1, s[48:51], s86 offen offset:2048
    ds_read_b128 v[16:19], v5 offset:6144
    s_waitcnt lgkmcnt(3)
    v_mfma_f32_16x16x32_bf16 v[28:31], v[204:207], v[20:23], v[28:31]
    ds_read_b128 v[20:23], v5 offset:6400
    s_waitcnt lgkmcnt(3)
    v_mfma_f32_16x16x32_bf16 v[24:27], v[208:211], v[8:11], v[24:27]
    buffer_load_dwordx4 v[96:99], v1, s[48:51], s86 offen offset:3072
    ds_read_b128 v[8:11], v5 offset:8192
    s_waitcnt lgkmcnt(3)
    v_mfma_f32_16x16x32_bf16 v[28:31], v[208:211], v[12:15], v[28:31]
    ds_read_b128 v[12:15], v5 offset:8448
    s_waitcnt lgkmcnt(3)
    v_mfma_f32_16x16x32_bf16 v[24:27], v[212:215], v[16:19], v[24:27]
    ds_read_b128 v[16:19], v5 offset:10240
    s_waitcnt lgkmcnt(3)
    v_mfma_f32_16x16x32_bf16 v[28:31], v[212:215], v[20:23], v[28:31]
    s_add_u32 s86, s86, 4096
    buffer_load_dwordx4 v[100:103], v1, s[48:51], s86 offen offset:0
    ds_read_b128 v[20:23], v5 offset:10496
    s_waitcnt lgkmcnt(3)
    v_mfma_f32_16x16x32_bf16 v[24:27], v[216:219], v[8:11], v[24:27]
    ds_read_b128 v[8:11], v5 offset:12288
    s_waitcnt lgkmcnt(3)
    v_mfma_f32_16x16x32_bf16 v[28:31], v[216:219], v[12:15], v[28:31]
    buffer_load_dwordx4 v[104:107], v1, s[48:51], s86 offen offset:1024
    ds_read_b128 v[12:15], v5 offset:12544
    s_waitcnt lgkmcnt(3)
    v_mfma_f32_16x16x32_bf16 v[24:27], v[220:223], v[16:19], v[24:27]
    ds_read_b128 v[16:19], v5 offset:14336
    s_waitcnt lgkmcnt(3)
    v_mfma_f32_16x16x32_bf16 v[28:31], v[220:223], v[20:23], v[28:31]
    buffer_load_dwordx4 v[108:111], v1, s[48:51], s86 offen offset:2048
    ds_read_b128 v[20:23], v5 offset:14592
    s_waitcnt lgkmcnt(3)
    v_mfma_f32_16x16x32_bf16 v[24:27], v[224:227], v[8:11], v[24:27]
    ds_read_b128 v[8:11], v5 offset:16384
    s_waitcnt lgkmcnt(3)
    v_mfma_f32_16x16x32_bf16 v[28:31], v[224:227], v[12:15], v[28:31]
    ds_read_b128 v[12:15], v5 offset:16640
    s_waitcnt lgkmcnt(3)
    v_mfma_f32_16x16x32_bf16 v[24:27], v[228:231], v[16:19], v[24:27]
    ds_read_b128 v[16:19], v5 offset:18432
    s_waitcnt lgkmcnt(3)
    v_mfma_f32_16x16x32_bf16 v[28:31], v[228:231], v[20:23], v[28:31]
    ds_read_b128 v[20:23], v5 offset:18688
    s_waitcnt lgkmcnt(3)
    v_mfma_f32_16x16x32_bf16 v[24:27], v[232:235], v[8:11], v[24:27]
    ds_read_b128 v[8:11], v5 offset:20480
    s_waitcnt lgkmcnt(3)
    v_mfma_f32_16x16x32_bf16 v[28:31], v[232:235], v[12:15], v[28:31]
    ds_read_b128 v[12:15], v5 offset:20736
    s_waitcnt lgkmcnt(3)
    v_mfma_f32_16x16x32_bf16 v[24:27], v[236:239], v[16:19], v[24:27]
    ds_read_b128 v[16:19], v5 offset:22528
    s_waitcnt lgkmcnt(3)
    v_mfma_f32_16x16x32_bf16 v[28:31], v[236:239], v[20:23], v[28:31]
    ds_read_b128 v[20:23], v5 offset:22784
    s_waitcnt lgkmcnt(3)
    v_mfma_f32_16x16x32_bf16 v[24:27], v[240:243], v[8:11], v[24:27]
    ds_read_b128 v[8:11], v5 offset:24576
    s_waitcnt lgkmcnt(3)
    v_mfma_f32_16x16x32_bf16 v[28:31], v[240:243], v[12:15], v[28:31]
    ds_read_b128 v[12:15], v5 offset:24832
    s_waitcnt lgkmcnt(3)
    v_mfma_f32_16x16x32_bf16 v[24:27], v[244:247], v[16:19], v[24:27]
    ds_read_b128 v[16:19], v5 offset:26624
    s_waitcnt lgkmcnt(3)
    v_mfma_f32_16x16x32_bf16 v[28:31], v[244:247], v[20:23], v[28:31]
    ds_read_b128 v[20:23], v5 offset:26880
    s_waitcnt lgkmcnt(3)
    v_mfma_f32_16x16x32_bf16 v[24:27], v[248:251], v[8:11], v[24:27]
    s_waitcnt lgkmcnt(2)
    v_mfma_f32_16x16x32_bf16 v[28:31], v[248:251], v[12:15], v[28:31]
    s_waitcnt lgkmcnt(1)
    v_mfma_f32_16x16x32_bf16 v[24:27], v[252:255], v[16:19], v[24:27]
    s_waitcnt lgkmcnt(0)
    v_mfma_f32_16x16x32_bf16 v[28:31], v[252:255], v[20:23], v[28:31]
    s_nop 5
    v_cvt_pk_bf16_f32 v20, v24, v25
    v_cvt_pk_bf16_f32 v21, v26, v27
    v_cvt_pk_bf16_f32 v22, v28, v29
    v_cvt_pk_bf16_f32 v23, v30, v31
    s_nop 0
    v_permlane16_swap_b32 v20, v22
    v_permlane16_swap_b32 v21, v23
    v_or_b32 v20, 1, v20
    s_cmp_eq_u32 s61, 0
    s_cbranch_scc1 Lxs25
    buffer_store_dwordx4 v[20:23], v1, s[32:35], s71 offen
Lxb26:
    ds_write_b128 v46, v[20:23] offset:57344
    v_dot2_f32_bf16 v32, v20, v34, 0
    v_dot2_f32_bf16 v33, v20, v20, 0
    v_dot2_f32_bf16 v32, v21, v34, v32
    v_dot2_f32_bf16 v33, v21, v21, v33
    v_dot2_f32_bf16 v32, v22, v34, v32
    v_dot2_f32_bf16 v33, v22, v22, v33
    v_dot2_f32_bf16 v32, v23, v34, v32
    v_dot2_f32_bf16 v33, v23, v23, v33
    v_mov_b32 v49, 0
    v_mov_b32 v50, 0
    v_mov_b32 v51, 0
    v_add_u32 v6, 28672, v1
    s_lshl_b32 s70, s52, 11
    s_add_u32 s70, s70, 106880
    v_add_u32 v7, s70, v1
    v_add_u32 v44, 106880, v1
    ds_write_b64 v35, v[32:33]
    s_mov_b64 exec, 1
    ds_write_b32 v45, v45
    s_mov_b64 exec, -1
    v_add_f32 v36, v36, v24
    v_add_f32 v37, v37, v25
    v_add_f32 v38, v38, v26
    v_add_f32 v39, v39, v27
    v_add_f32 v40, v40, v28
    v_add_f32 v41, v41, v29
    v_add_f32 v42, v42, v30
    v_add_f32 v43, v43, v31
    s_waitcnt vmcnt(0)
    s_add_u32 m0, s7, 28672
    s_add_u32 s68, s9, 0
    buffer_load_dwordx4 v1, s[32:35], s68 offen sc1 lds
    s_add_u32 m0, s7, 35840
    s_add_u32 s68, s9, 7168
    buffer_load_dwordx4 v1, s[32:35], s68 offen sc1 lds
    s_add_u32 m0, s7, 43008
    s_add_u32 s68, s9, 14336
    buffer_load_dwordx4 v1, s[32:35], s68 offen sc1 lds
    s_add_u32 m0, s7, 50176
    s_add_u32 s68, s9, 21504
    buffer_load_dwordx4 v1, s[32:35], s68 offen sc1 lds
    v_pk_add_f32 v[164:165], v[164:165], v[166:167]
    v_add_f32 v168, v168, v170
    v_pk_add_f32 v[164:165], v[164:165], v[168:169]
    v_add_f32 v164, v164, v165
    v_mov_b32 v165, v164
    s_nop 1
    v_permlane32_swap_b32 v164, v165
    v_add_f32 v164, v164, v165
    v_cvt_pk_bf16_f32 v48, v164, v164
    v_and_b32 v165, 0xffff0000, v48
    v_sub_f32 v165, v164, v165
    v_cvt_pk_bf16_f32 v48, v164, v165
    s_waitcnt vmcnt(0)
    ds_read_b32 v8, v47 offset:0
    ds_read_b32 v9, v47 offset:7168
    ds_read_b32 v10, v47 offset:14336
    ds_read_b32 v11, v47 offset:21504
    s_waitcnt lgkmcnt(2)
    v_and_b32 v8, v8, v9
    s_waitcnt lgkmcnt(0)
    v_and_b32 v10, v10, v11
    v_and_b32 v8, 1, v8
    v_and_b32 v8, v8, v10
    v_cmp_eq_u32 vcc, 0, v8
    s_mov_b32 s97, 0
    s_nop 0
    s_cbranch_vccnz Lfr27
Lfb28:
    s_add_u32 m0, s4, 57344
    s_add_u32 s68, s4, s8
    buffer_load_dwordx4 v1, s[32:35], s68 offen sc1 lds
    s_add_u32 m0, s5, 57344
    s_add_u32 s68, s5, s8
    buffer_load_dwordx4 v1, s[32:35], s68 offen sc1 lds
    s_add_u32 m0, s6, 57344
    s_add_u32 s68, s6, s8
    buffer_load_dwordx4 v1, s[32:35], s68 offen sc1 lds
    buffer_load_dwordx4 v[112:115], v1, s[48:51], s86 offen offset:3072
    s_add_u32 s86, s86, 4096
    buffer_load_dwordx4 v[116:119], v1, s[48:51], s86 offen offset:0
    v_and_b32 v46, 7, v2
    v_mul_u32_u24 v46, 260, v46
    v_add_u32 v46, 86016, v46
    s_lshl_b32 s21, s52, 8
    s_add_u32 s21, s21, 32768
    s_mov_b32 m0, s21
    s_barrier
    ds_read_b128 v[8:11], v6 offset:0
    ds_read_b128 v[12:15], v6 offset:1024
    ds_read_b128 v[16:19], v6 offset:2048
    s_setprio 1
    s_waitcnt lgkmcnt(2)
    v_mfma_f32_32x32x16_bf16 v[180:195], v[52:55], v[8:11], 0
    ds_read_b128 v[20:23], v6 offset:3072
    buffer_load_dwordx4 v[120:123], v1, s[48:51], s86 offen offset:1024
    s_waitcnt lgkmcnt(2)
    v_mfma_f32_32x32x16_bf16 v[180:195], v[56:59], v[12:15], v[180:195]
    ds_read_b128 v[8:11], v6 offset:4096
    buffer_load_dwordx4 v[124:127], v1, s[48:51], s86 offen offset:2048
    s_waitcnt lgkmcnt(2)
    v_mfma_f32_32x32x16_bf16 v[180:195], v[60:63], v[16:19], v[180:195]
    ds_read_b128 v[12:15], v6 offset:5120
    s_setprio 0
    s_waitcnt lgkmcnt(2)
    v_mfma_f32_32x32x16_bf16 v[180:195], v[64:67], v[20:23], v[180:195]
    ds_read_b128 v[16:19], v6 offset:6144
    s_waitcnt vmcnt(4)
    ds_read_b32 v24, v47 offset:28672
    ds_read_b32 v25, v47 offset:35840
    ds_read_b32 v26, v47 offset:43008
    ds_read_b32 v27, v47 offset:50176
    buffer_load_dwordx4 v[128:131], v1, s[48:51], s86 offen offset:3072
    s_setprio 1
    s_waitcnt lgkmcnt(6)
    v_mfma_f32_32x32x16_bf16 v[180:195], v[68:71], v[8:11], v[180:195]
    ds_read_b128 v[20:23], v6 offset:7168
    s_add_u32 s86, s86, 4096
    buffer_load_dwordx4 v[132:135], v1, s[48:51], s86 offen offset:0
    s_waitcnt lgkmcnt(6)
    v_mfma_f32_32x32x16_bf16 v[180:195], v[72:75], v[12:15], v[180:195]
    ds_read_b128 v[8:11], v6 offset:8192
    s_waitcnt lgkmcnt(4)
    v_and_b32 v24, v24, v25
    s_waitcnt lgkmcnt(2)
    v_and_b32 v26, v26, v27
    v_and_b32 v24, 1, v24
    v_and_b32 v24, v24, v26
    v_cmp_eq_u32 vcc, 0, v24
    s_mov_b32 s97, 0
    s_nop 0
    s_cbranch_vccnz Lfr29
Lfb30:
    ds_write_addtid_b32 v44 offset:63488
    v_mfma_f32_32x32x16_bf16 v[180:195], v[76:79], v[16:19], v[180:195]
    ds_read_b128 v[12:15], v6 offset:9216
    buffer_load_dwordx4 v[136:139], v1, s[48:51], s86 offen offset:1024
    s_setprio 0
    s_waitcnt lgkmcnt(3)
    v_mfma_f32_32x32x16_bf16 v[180:195], v[80:83], v[20:23], v[180:195]
    ds_read_b128 v[16:19], v6 offset:10240
    buffer_load_dwordx4 v[140:143], v1, s[48:51], s86 offen offset:2048
    s_setprio 1
    s_waitcnt lgkmcnt(3)
    v_mfma_f32_32x32x16_bf16 v[180:195], v[84:87], v[8:11], v[180:195]
    ds_read_b128 v[20:23], v6 offset:11264
    s_xor_b32 s69, s57, 1
    s_mul_i32 s70, s69, 28
    s_add_u32 s70, s70, s82
    s_lshl_b32 s71, s70, 10
    s_add_u32 s12, s71, 10485760
    s_waitcnt lgkmcnt(2)
    v_mfma_f32_32x32x16_bf16 v[180:195], v[88:91], v[12:15], v[180:195]
    ds_read_b128 v[8:11], v6 offset:12288
    s_add_u32 s13, s71, 12582912
    s_lshl1_add_u32 s14, s71, 16777216
    s_lshl_b32 s69, s69, 5
    s_add_u32 s69, s69, s82
    s_lshl2_add_u32 s19, s69, 33579008
    buffer_load_dwordx4 v[144:147], v1, s[48:51], s86 offen offset:3072
    s_waitcnt lgkmcnt(2)
    v_mfma_f32_32x32x16_bf16 v[180:195], v[92:95], v[16:19], v[180:195]
    ds_read_b128 v[12:15], v6 offset:13312
    s_add_u32 s86, s86, 4096
    buffer_load_dwordx4 v[148:151], v1, s[48:51], s86 offen offset:0
    s_setprio 0
    s_waitcnt lgkmcnt(2)
    v_mfma_f32_32x32x16_bf16 v[180:195], v[96:99], v[20:23], v[180:195]
    ds_read_b128 v[16:19], v6 offset:14336
    s_xor_b32 s69, s57, 0
    s_mul_i32 s70, s69, 28
    s_add_u32 s70, s70, s82
    s_lshl_b32 s71, s70, 10
    s_add_u32 s15, s71, 10485760
    ds_read_b32 v4, v46 offset:10240
    s_setprio 1
    s_waitcnt lgkmcnt(3)
    v_mfma_f32_32x32x16_bf16 v[180:195], v[100:103], v[8:11], v[180:195]
    ds_read_b128 v[20:23], v6 offset:15360
    s_add_u32 s16, s71, 12582912
    s_lshl1_add_u32 s17, s71, 16777216
    s_lshl_b32 s69, s69, 5
    s_add_u32 s69, s69, s82
    s_lshl2_add_u32 s18, s69, 33579008
    buffer_load_dwordx4 v[152:155], v1, s[48:51], s86 offen offset:1024
    s_waitcnt lgkmcnt(3)
    v_mfma_f32_32x32x16_bf16 v[180:195], v[104:107], v[12:15], v[180:195]
    ds_read_b128 v[8:11], v6 offset:16384
    s_waitcnt lgkmcnt(2)
    v_cmp_eq_u32 vcc, 0, v4
    buffer_load_dwordx4 v[156:159], v1, s[48:51], s86 offen offset:2048
    s_nop 0
    s_cbranch_vccnz Lls31
Llb32:
    v_mfma_f32_32x32x16_bf16 v[180:195], v[108:111], v[16:19], v[180:195]
    ds_read_b128 v[12:15], v6 offset:28672
    s_xor_b32 s72, s57, 1
    s_lshl_b32 s72, s72, 5
    s_lshr_b32 s74, s82, 2
    s_add_u32 s72, s72, s74
    s_lshl2_add_u32 s72, s72, 33579008
    s_setprio 0
    s_waitcnt vmcnt(11) lgkmcnt(2)
    v_mfma_f32_32x32x16_bf16 v[180:195], v[112:115], v[20:23], v[180:195]
    ds_read_b128 v[16:19], v6 offset:29696
    s_bfe_u32 s74, s82, 0x10001
    s_mul_i32 s74, s74, 8192
    s_add_u32 s72, s72, s74
    buffer_load_dwordx4 v[160:163], v1, s[48:51], s86 offen offset:3072
    s_setprio 1
    s_waitcnt vmcnt(11) lgkmcnt(2)
    v_mfma_f32_32x32x16_bf16 v[180:195], v[116:119], v[8:11], v[180:195]
    ds_read_b128 v[20:23], v6 offset:30720
    s_waitcnt lgkmcnt(2)
    v_mfma_f32_32x32x16_bf16 v[164:179], v[52:55], v[12:15], 0
    ds_read_b128 v[8:11], v6 offset:31744
    s_mul_i32 s74, s57, 28
    s_lshr_b32 s22, s82, 2
    s_add_u32 s74, s74, s22
    s_lshl_b32 s74, s74, 10
    s_and_b32 s22, s82, 1
    buffer_load_dwordx4 v[200:203], v1, s[48:51], s87 offen offset:0
    s_waitcnt lgkmcnt(2)
    v_mfma_f32_32x32x16_bf16 v[164:179], v[56:59], v[16:19], v[164:179]
    ds_read_b128 v[12:15], v6 offset:17408
    s_setprio 0
    s_waitcnt lgkmcnt(2)
    v_mfma_f32_32x32x16_bf16 v[164:179], v[60:63], v[20:23], v[164:179]
    ds_read_b128 v[16:19], v6 offset:18432
    s_lshl_b32 s71, s22, 21
    s_add_u32 s71, s71, s74
    s_add_u32 s71, s71, 10485760
    s_lshl_b32 s22, s22, 10
    s_lshl1_add_u32 s74, s74, s22
    buffer_load_dwordx4 v[204:207], v1, s[48:51], s87 offen offset:1024
    s_setprio 1
    s_waitcnt lgkmcnt(2)
    v_mfma_f32_32x32x16_bf16 v[164:179], v[64:67], v[8:11], v[164:179]
    ds_read_b128 v[20:23], v6 offset:19456
    s_add_u32 s74, s74, 16777216
    s_bitcmp1_b32 s82, 1
    s_cselect_b32 s74, s71, s74
    s_cselect_b32 s22, 7, 14
    s_lshl_b32 s22, s22, 10
    s_waitcnt vmcnt(12) lgkmcnt(2)
    v_mfma_f32_32x32x16_bf16 v[180:195], v[120:123], v[12:15], v[180:195]
    ds_read_b128 v[8:11], v6 offset:20480
    buffer_load_dwordx4 v[208:211], v1, s[48:51], s87 offen offset:2048
    s_waitcnt vmcnt(12) lgkmcnt(2)
    v_mfma_f32_32x32x16_bf16 v[180:195], v[124:127], v[16:19], v[180:195]
    ds_read_b128 v[12:15], v6 offset:21504
    s_lshl1_add_u32 s75, s22, s74
    s_sub_u32 s22, s22, 1024
    v_lshrrev_b32 v28, 5, v2
    v_mad_u32_u24 v5, v28, s22, v5
    s_mul_i32 s76, s57, 28672
    s_setprio 0
    s_waitcnt vmcnt(11) lgkmcnt(2)
    v_mfma_f32_32x32x16_bf16 v[180:195], v[128:131], v[20:23], v[180:195]
    ds_read_b128 v[16:19], v6 offset:22528
    s_lshl_b32 s77, s82, 5
    s_add_u32 s76, s76, s77
    s_mov_b32 s36, s28
    s_mov_b32 s37, s29
    s_mov_b32 s38, 1835008
    buffer_load_dwordx4 v[212:215], v1, s[48:51], s87 offen offset:3072
    s_setprio 1
    s_waitcnt vmcnt(11) lgkmcnt(2)
    v_mfma_f32_32x32x16_bf16 v[180:195], v[132:135], v[8:11], v[180:195]
    ds_read_b128 v[20:23], v6 offset:23552
    s_waitcnt vmcnt(10) lgkmcnt(2)
    v_mfma_f32_32x32x16_bf16 v[180:195], v[136:139], v[12:15], v[180:195]
    ds_read_b128 v[8:11], v6 offset:24576
    s_mov_b32 s39, 0x20000
    s_add_u32 s87, s87, 4096
    buffer_load_dwordx4 v[216:219], v1, s[48:51], s87 offen offset:0
    s_waitcnt vmcnt(10) lgkmcnt(2)
    v_mfma_f32_32x32x16_bf16 v[180:195], v[140:143], v[16:19], v[180:195]
    ds_read_b128 v[12:15], v6 offset:25600
    ds_read_b32 v4, v46 offset:8192
    s_setprio 0
    s_waitcnt vmcnt(9) lgkmcnt(3)
    v_mfma_f32_32x32x16_bf16 v[180:195], v[144:147], v[20:23], v[180:195]
    ds_read_b128 v[16:19], v6 offset:26624
    buffer_load_dwordx4 v[220:223], v1, s[48:51], s87 offen offset:1024
    s_setprio 1
    s_waitcnt vmcnt(9) lgkmcnt(3)
    v_mfma_f32_32x32x16_bf16 v[180:195], v[148:151], v[8:11], v[180:195]
    ds_read_b128 v[20:23], v6 offset:27648
    s_waitcnt lgkmcnt(2)
    v_cmp_eq_u32 vcc, 0, v4
    s_nop 1
    s_cbranch_vccnz Lls33
Llb34:
    ds_read_b128 v[196:199], v44 offset:44544
    s_waitcnt vmcnt(8)
    v_mfma_f32_32x32x16_bf16 v[180:195], v[152:155], v[12:15], v[180:195]
    ds_read_b128 v[8:11], v6 offset:32768
    buffer_load_dwordx4 v[224:227], v1, s[48:51], s87 offen offset:2048
    s_waitcnt vmcnt(8) lgkmcnt(3)
    v_mfma_f32_32x32x16_bf16 v[180:195], v[156:159], v[16:19], v[180:195]
    ds_read_b128 v[12:15], v6 offset:33792
    s_setprio 0
    s_waitcnt vmcnt(7) lgkmcnt(3)
    v_mfma_f32_32x32x16_bf16 v[180:195], v[160:163], v[20:23], v[180:195]
    ds_read_b128 v[16:19], v6 offset:34816
    buffer_load_dwordx4 v[228:231], v1, s[48:51], s87 offen offset:3072
    s_waitcnt lgkmcnt(3)
    v_mfma_f32_32x32x16_bf16 v[180:195], v[48:51], v[196:199], v[180:195]
    s_setprio 1
    s_waitcnt lgkmcnt(2)
    v_mfma_f32_32x32x16_bf16 v[164:179], v[68:71], v[8:11], v[164:179]
    ds_read_b128 v[20:23], v6 offset:35840
    s_waitcnt lgkmcnt(2)
    v_mfma_f32_32x32x16_bf16 v[164:179], v[72:75], v[12:15], v[164:179]
    ds_read_b128 v[8:11], v6 offset:36864
    s_add_u32 s87, s87, 4096
    buffer_load_dwordx4 v[232:235], v1, s[48:51], s87 offen offset:0
    s_nop 2
    v_mul_f32 v24, v180, v180
    v_mul_f32 v25, v181, v181
    v_mul_f32 v26, v182, v182
    v_mul_f32 v27, v183, v183
    v_mul_f32 v28, v184, v184
    v_mul_f32 v29, v185, v185
    s_waitcnt lgkmcnt(2)
    v_mfma_f32_32x32x16_bf16 v[164:179], v[76:79], v[16:19], v[164:179]
    ds_read_b128 v[12:15], v6 offset:37888
    v_mul_f32 v30, v186, v186
    v_mul_f32 v31, v187, v187
    v_fma_f32 v24, v24, v197, v198
    v_fma_f32 v25, v25, v197, v198
    v_fma_f32 v26, v26, v197, v198
    s_setprio 0
    s_waitcnt lgkmcnt(2)
    v_mfma_f32_32x32x16_bf16 v[164:179], v[80:83], v[20:23], v[164:179]
    ds_read_b128 v[16:19], v6 offset:38912
    buffer_load_dwordx4 v[236:239], v1, s[48:51], s87 offen offset:1024
    v_fma_f32 v27, v27, v197, v198
    v_fma_f32 v28, v28, v197, v198
    v_fma_f32 v29, v29, v197, v198
    v_fma_f32 v30, v30, v197, v198
    v_fma_f32 v31, v31, v197, v198
    v_mul_f32 v24, v24, v180
    s_setprio 1
    s_waitcnt lgkmcnt(2)
    v_mfma_f32_32x32x16_bf16 v[164:179], v[84:87], v[8:11], v[164:179]
    ds_read_b128 v[20:23], v6 offset:39936
    v_mul_f32 v25, v25, v181
    v_mul_f32 v26, v26, v182
    v_mul_f32 v27, v27, v183
    v_mul_f32 v28, v28, v184
    v_mul_f32 v29, v29, v185
    s_waitcnt lgkmcnt(2)
    v_mfma_f32_32x32x16_bf16 v[164:179], v[88:91], v[12:15], v[164:179]
    ds_read_b128 v[8:11], v6 offset:40960
    buffer_load_dwordx4 v[240:243], v1, s[48:51], s87 offen offset:2048
    v_mul_f32 v30, v30, v186
    v_mul_f32 v31, v31, v187
    v_exp_f32 v24, v24
    v_exp_f32 v25, v25
    s_waitcnt lgkmcnt(2)
    v_mfma_f32_32x32x16_bf16 v[164:179], v[92:95], v[16:19], v[164:179]
    ds_read_b128 v[12:15], v6 offset:41984
    v_exp_f32 v26, v26
    v_exp_f32 v27, v27
    v_exp_f32 v28, v28
    s_setprio 0
    s_waitcnt lgkmcnt(2)
    v_mfma_f32_32x32x16_bf16 v[164:179], v[96:99], v[20:23], v[164:179]
    ds_read_b128 v[16:19], v6 offset:43008
    buffer_load_dwordx4 v[244:247], v1, s[48:51], s87 offen offset:3072
    v_exp_f32 v29, v29
    v_exp_f32 v30, v30
    v_exp_f32 v31, v31
    s_setprio 1
    s_waitcnt lgkmcnt(2)
    v_mfma_f32_32x32x16_bf16 v[164:179], v[100:103], v[8:11], v[164:179]
    ds_read_b128 v[20:23], v6 offset:44032
    v_fma_f32 v24, v24, v199, v199
    v_fma_f32 v25, v25, v199, v199
    v_fma_f32 v26, v26, v199, v199
    v_fma_f32 v27, v27, v199, v199
    s_waitcnt lgkmcnt(2)
    v_mfma_f32_32x32x16_bf16 v[164:179], v[104:107], v[12:15], v[164:179]
    ds_read_b128 v[8:11], v6 offset:45056
    s_add_u32 s87, s87, 4096
    buffer_load_dwordx4 v[248:251], v1, s[48:51], s87 offen offset:0
    v_fma_f32 v28, v28, v199, v199
    v_fma_f32 v29, v29, v199, v199
    v_fma_f32 v30, v30, v199, v199
    v_fma_f32 v31, v31, v199, v199
    v_rcp_f32 v24, v24
    s_waitcnt lgkmcnt(2)
    v_mfma_f32_32x32x16_bf16 v[164:179], v[108:111], v[16:19], v[164:179]
    ds_read_b128 v[12:15], v6 offset:46080
    v_rcp_f32 v25, v25
    v_rcp_f32 v26, v26
    v_rcp_f32 v27, v27
    s_setprio 0
    s_waitcnt lgkmcnt(2)
    v_mfma_f32_32x32x16_bf16 v[164:179], v[112:115], v[20:23], v[164:179]
    ds_read_b128 v[16:19], v6 offset:47104
    buffer_load_dwordx4 v[252:255], v1, s[48:51], s87 offen offset:1024
    v_rcp_f32 v28, v28
    v_rcp_f32 v29, v29
    v_rcp_f32 v30, v30
    s_setprio 1
    s_waitcnt lgkmcnt(2)
    v_mfma_f32_32x32x16_bf16 v[164:179], v[116:119], v[8:11], v[164:179]
    ds_read_b128 v[20:23], v6 offset:48128
    v_rcp_f32 v31, v31
    v_mul_f32 v24, v24, v180
    v_mul_f32 v25, v25, v181
    s_waitcnt lgkmcnt(2)
    v_mfma_f32_32x32x16_bf16 v[164:179], v[120:123], v[12:15], v[164:179]
    ds_read_b128 v[8:11], v6 offset:49152
    buffer_load_dwordx4 v[52:55], v1, s[48:51], s87 offen offset:2048
    v_mul_f32 v26, v26, v182
    v_mul_f32 v27, v27, v183
    v_mul_f32 v28, v28, v184
    v_mul_f32 v29, v29, v185
    v_mul_f32 v30, v30, v186
    v_mul_f32 v31, v31, v187
    s_waitcnt lgkmcnt(2)
    v_mfma_f32_32x32x16_bf16 v[164:179], v[124:127], v[16:19], v[164:179]
    ds_read_b128 v[12:15], v6 offset:50176
    buffer_load_dwordx4 v[56:59], v1, s[48:51], s87 offen offset:3072
    v_cvt_pk_bf16_f32 v32, v24, v25
    v_cvt_pk_bf16_f32 v33, v26, v27
    v_cvt_pk_bf16_f32 v34, v28, v29
    v_cvt_pk_bf16_f32 v35, v30, v31
    ds_write_b128 v7, v[32:35] offset:0
    ds_write_addtid_b32 v44 offset:53248
    s_setprio 0
    s_waitcnt lgkmcnt(4)
    v_mfma_f32_32x32x16_bf16 v[164:179], v[128:131], v[20:23], v[164:179]
    ds_read_b128 v[16:19], v6 offset:51200
    v_mul_f32 v24, v188, v188
    v_mul_f32 v25, v189, v189
    v_mul_f32 v26, v190, v190
    v_mul_f32 v27, v191, v191
    v_mul_f32 v28, v192, v192
    v_mul_f32 v29, v193, v193
    s_setprio 1
    s_waitcnt lgkmcnt(4)
    v_mfma_f32_32x32x16_bf16 v[164:179], v[132:135], v[8:11], v[164:179]
    ds_read_b128 v[20:23], v6 offset:52224
    s_add_u32 s87, s87, 4096
    buffer_load_dwordx4 v[60:63], v1, s[48:51], s87 offen offset:0
    v_mul_f32 v30, v194, v194
    v_mul_f32 v31, v195, v195
    v_fma_f32 v24, v24, v197, v198
    v_fma_f32 v25, v25, v197, v198
    v_fma_f32 v26, v26, v197, v198
    v_fma_f32 v27, v27, v197, v198
    s_waitcnt lgkmcnt(4)
    v_mfma_f32_32x32x16_bf16 v[164:179], v[136:139], v[12:15], v[164:179]
    ds_read_b128 v[8:11], v6 offset:53248
    v_fma_f32 v28, v28, v197, v198
    v_fma_f32 v29, v29, v197, v198
    v_fma_f32 v30, v30, v197, v198
    v_fma_f32 v31, v31, v197, v198
    v_mul_f32 v24, v24, v188
    v_mul_f32 v25, v25, v189
    s_waitcnt lgkmcnt(2)
    v_mfma_f32_32x32x16_bf16 v[164:179], v[140:143], v[16:19], v[164:179]
    ds_read_b128 v[12:15], v6 offset:54272
    buffer_load_dwordx4 v[64:67], v1, s[48:51], s87 offen offset:1024
    v_mul_f32 v26, v26, v190
    v_mul_f32 v27, v27, v191
    v_mul_f32 v28, v28, v192
    v_mul_f32 v29, v29, v193
    v_mul_f32 v30, v30, v194
    v_mul_f32 v31, v31, v195
    ds_read_b32 v4, v46 offset:0
    s_setprio 0
    s_waitcnt lgkmcnt(3)
    v_mfma_f32_32x32x16_bf16 v[164:179], v[144:147], v[20:23], v[164:179]
    ds_read_b128 v[16:19], v6 offset:55296
    buffer_load_dwordx4 v[68:71], v1, s[48:51], s87 offen offset:2048
    v_exp_f32 v24, v24
    v_exp_f32 v25, v25
    v_exp_f32 v26, v26
    s_setprio 1
    s_waitcnt lgkmcnt(3)
    v_mfma_f32_32x32x16_bf16 v[164:179], v[148:151], v[8:11], v[164:179]
    ds_read_b128 v[20:23], v6 offset:56320
    s_waitcnt lgkmcnt(2)
    v_cmp_eq_u32 vcc, 0, v4
    v_exp_f32 v27, v27
    v_exp_f32 v28, v28
    v_exp_f32 v29, v29
    s_cbranch_vccnz Lls35
Llb36:
    v_mfma_f32_32x32x16_bf16 v[164:179], v[152:155], v[12:15], v[164:179]
    ds_read_b128 v[8:11], v44 offset:0
    buffer_load_dwordx4 v[72:75], v1, s[48:51], s87 offen offset:3072
    v_exp_f32 v30, v30
    v_exp_f32 v31, v31
    v_fma_f32 v24, v24, v199, v199
    v_fma_f32 v25, v25, v199, v199
    s_waitcnt lgkmcnt(2)
    v_mfma_f32_32x32x16_bf16 v[164:179], v[156:159], v[16:19], v[164:179]
    v_fma_f32 v26, v26, v199, v199
    v_fma_f32 v27, v27, v199, v199
    v_fma_f32 v28, v28, v199, v199
    v_fma_f32 v29, v29, v199, v199
    v_fma_f32 v30, v30, v199, v199
    v_fma_f32 v31, v31, v199, v199
    s_setprio 0
    s_waitcnt lgkmcnt(1)
    v_mfma_f32_32x32x16_bf16 v[164:179], v[160:163], v[20:23], v[164:179]
    ds_read_b128 v[12:15], v44 offset:2048
    s_add_u32 s87, s87, 4096
    buffer_load_dwordx4 v[76:79], v1, s[48:51], s87 offen offset:0
    v_rcp_f32 v24, v24
    v_rcp_f32 v25, v25
    v_rcp_f32 v26, v26
    ds_read_b128 v[160:163], v44 offset:45568
    s_setprio 1
    s_waitcnt vmcnt(20) lgkmcnt(2)
    v_mfma_f32_32x32x16_bf16 v[112:127], v[200:203], v[8:11], 0
    v_rcp_f32 v27, v27
    v_rcp_f32 v28, v28
    v_rcp_f32 v29, v29
    s_waitcnt vmcnt(19)
    v_mfma_f32_32x32x16_bf16 v[128:143], v[204:207], v[8:11], 0
    ds_read_b128 v[16:19], v44 offset:4096
    buffer_load_dwordx4 v[80:83], v1, s[48:51], s87 offen offset:1024
    v_rcp_f32 v30, v30
    v_rcp_f32 v31, v31
    v_mul_f32 v24, v24, v188
    v_mul_f32 v25, v25, v189
    s_waitcnt lgkmcnt(1)
    v_mfma_f32_32x32x16_bf16 v[164:179], v[48:51], v[160:163], v[164:179]
    s_waitcnt vmcnt(19)
    v_mfma_f32_32x32x16_bf16 v[112:127], v[208:211], v[12:15], v[112:127]
    buffer_load_dwordx4 v[84:87], v1, s[48:51], s87 offen offset:2048
    v_mul_f32 v26, v26, v190
    v_mul_f32 v27, v27, v191
    v_mul_f32 v28, v28, v192
    v_mul_f32 v29, v29, v193
    v_mul_f32 v30, v30, v194
    v_mul_f32 v31, v31, v195
    global_load_dwordx4 v[48:51], v1, s[94:95] offset:-1024
    s_setprio 0
    s_waitcnt vmcnt(20)
    v_mfma_f32_32x32x16_bf16 v[128:143], v[212:215], v[12:15], v[128:143]
    ds_read_b128 v[20:23], v44 offset:6144
    v_cvt_pk_bf16_f32 v32, v24, v25
    v_cvt_pk_bf16_f32 v33, v26, v27
    v_cvt_pk_bf16_f32 v34, v28, v29
    v_cvt_pk_bf16_f32 v35, v30, v31
    ds_write_b128 v7, v[32:35] offset:1024
    ds_write_addtid_b32 v44 offset:55296
    s_setprio 1
    s_waitcnt vmcnt(19) lgkmcnt(3)
    v_mfma_f32_32x32x16_bf16 v[112:127], v[216:219], v[16:19], v[112:127]
    buffer_load_dwordx4 v[88:91], v1, s[48:51], s87 offen offset:3072
    v_mul_f32 v24, v164, v164
    v_mul_f32 v25, v165, v165
    v_mul_f32 v26, v166, v166
    v_mul_f32 v27, v167, v167
    v_mul_f32 v28, v168, v168
    v_mul_f32 v29, v169, v169
    s_waitcnt vmcnt(19)
    v_mfma_f32_32x32x16_bf16 v[128:143], v[220:223], v[16:19], v[128:143]
    ds_read_b128 v[8:11], v44 offset:8192
    v_mul_f32 v30, v170, v170
    v_mul_f32 v31, v171, v171
    v_fma_f32 v24, v24, v161, v162
    v_fma_f32 v25, v25, v161, v162
    v_fma_f32 v26, v26, v161, v162
    v_fma_f32 v27, v27, v161, v162
    s_waitcnt vmcnt(18) lgkmcnt(3)
    v_mfma_f32_32x32x16_bf16 v[112:127], v[224:227], v[20:23], v[112:127]
    s_add_u32 s87, s87, 4096
    buffer_load_dwordx4 v[92:95], v1, s[48:51], s87 offen offset:0
    v_fma_f32 v28, v28, v161, v162
    v_fma_f32 v29, v29, v161, v162
    v_fma_f32 v30, v30, v161, v162
    v_fma_f32 v31, v31, v161, v162
    v_mul_f32 v24, v24, v164
    v_mul_f32 v25, v25, v165
    s_setprio 0
    s_waitcnt vmcnt(18)
    v_mfma_f32_32x32x16_bf16 v[128:143], v[228:231], v[20:23], v[128:143]
    ds_read_b128 v[12:15], v44 offset:10240
    buffer_load_dwordx4 v[96:99], v1, s[48:51], s87 offen offset:1024
    v_mul_f32 v26, v26, v166
    v_mul_f32 v27, v27, v167
    v_mul_f32 v28, v28, v168
    v_mul_f32 v29, v29, v169
    v_mul_f32 v30, v30, v170
    v_mul_f32 v31, v31, v171
    s_setprio 1
    s_waitcnt vmcnt(18) lgkmcnt(1)
    v_mfma_f32_32x32x16_bf16 v[112:127], v[232:235], v[8:11], v[112:127]
    v_exp_f32 v24, v24
    v_exp_f32 v25, v25
    v_exp_f32 v26, v26
    ds_read_b32 v4, v46 offset:2048
    s_waitcnt vmcnt(17)
    v_mfma_f32_32x32x16_bf16 v[128:143], v[236:239], v[8:11], v[128:143]
    ds_read_b128 v[16:19], v44 offset:12288
    buffer_load_dwordx4 v[100:103], v1, s[48:51], s87 offen offset:2048
    v_exp_f32 v27, v27
    v_exp_f32 v28, v28
    v_exp_f32 v29, v29
    s_waitcnt vmcnt(17) lgkmcnt(2)
    v_mfma_f32_32x32x16_bf16 v[112:127], v[240:243], v[12:15], v[112:127]
    s_waitcnt lgkmcnt(1)
    v_cmp_eq_u32 vcc, 0, v4
    v_exp_f32 v30, v30
    v_exp_f32 v31, v31
    v_fma_f32 v24, v24, v163, v163
    v_fma_f32 v25, v25, v163, v163
    s_cbranch_vccnz Lls37
Llb38:
    s_setprio 0
    s_waitcnt vmcnt(16)
    v_mfma_f32_32x32x16_bf16 v[128:143], v[244:247], v[12:15], v[128:143]
    ds_read_b128 v[20:23], v44 offset:1024
    buffer_load_dwordx4 v[104:107], v1, s[48:51], s87 offen offset:3072
    v_fma_f32 v26, v26, v163, v163
    v_fma_f32 v27, v27, v163, v163
    v_fma_f32 v28, v28, v163, v163
    v_fma_f32 v29, v29, v163, v163
    v_fma_f32 v30, v30, v163, v163
    v_fma_f32 v31, v31, v163, v163
    s_setprio 1
    s_waitcnt vmcnt(16) lgkmcnt(1)
    v_mfma_f32_32x32x16_bf16 v[112:127], v[248:251], v[16:19], v[112:127]
    ds_read_b128 v[8:11], v44 offset:3072
    v_rcp_f32 v24, v24
    v_rcp_f32 v25, v25
    v_rcp_f32 v26, v26
    s_waitcnt vmcnt(15)
    v_mfma_f32_32x32x16_bf16 v[128:143], v[252:255], v[16:19], v[128:143]
    ds_read_b128 v[12:15], v44 offset:5120
    v_rcp_f32 v27, v27
    v_rcp_f32 v28, v28
    v_rcp_f32 v29, v29
    s_waitcnt vmcnt(14) lgkmcnt(2)
    v_mfma_f32_32x32x16_bf16 v[112:127], v[52:55], v[20:23], v[112:127]
    ds_read_b128 v[16:19], v44 offset:7168
    v_rcp_f32 v30, v30
    v_rcp_f32 v31, v31
    v_mul_f32 v24, v24, v164
    v_mul_f32 v25, v25, v165
    s_setprio 0
    s_waitcnt vmcnt(13) lgkmcnt(2)
    v_mfma_f32_32x32x16_bf16 v[112:127], v[56:59], v[8:11], v[112:127]
    ds_read_b128 v[20:23], v44 offset:9216
    v_mul_f32 v26, v26, v166
    v_mul_f32 v27, v27, v167
    v_mul_f32 v28, v28, v168
    v_mul_f32 v29, v29, v169
    v_mul_f32 v30, v30, v170
    v_mul_f32 v31, v31, v171
    s_setprio 1
    s_waitcnt vmcnt(12) lgkmcnt(2)
    v_mfma_f32_32x32x16_bf16 v[112:127], v[60:63], v[12:15], v[112:127]
    ds_read_b128 v[8:11], v44 offset:11264
    v_cvt_pk_bf16_f32 v32, v24, v25
    v_cvt_pk_bf16_f32 v33, v26, v27
    v_cvt_pk_bf16_f32 v34, v28, v29
    v_cvt_pk_bf16_f32 v35, v30, v31
    ds_write_b128 v7, v[32:35] offset:14336
    ds_write_addtid_b32 v44 offset:57344
    s_waitcnt vmcnt(11) lgkmcnt(4)
    v_mfma_f32_32x32x16_bf16 v[112:127], v[64:67], v[16:19], v[112:127]
    ds_read_b128 v[12:15], v44 offset:13312
    v_mul_f32 v24, v172, v172
    v_mul_f32 v25, v173, v173
    v_mul_f32 v26, v174, v174
    v_mul_f32 v27, v175, v175
    v_mul_f32 v28, v176, v176
    v_mul_f32 v29, v177, v177
    s_waitcnt vmcnt(10) lgkmcnt(4)
    v_mfma_f32_32x32x16_bf16 v[112:127], v[68:71], v[20:23], v[112:127]
    ds_read_b128 v[16:19], v44 offset:1024
    v_mul_f32 v30, v178, v178
    v_mul_f32 v31, v179, v179
    v_fma_f32 v24, v24, v161, v162
    v_fma_f32 v25, v25, v161, v162
    v_fma_f32 v26, v26, v161, v162
    v_fma_f32 v27, v27, v161, v162
    s_setprio 0
    s_waitcnt vmcnt(9) lgkmcnt(4)
    v_mfma_f32_32x32x16_bf16 v[112:127], v[72:75], v[8:11], v[112:127]
    ds_read_b128 v[20:23], v44 offset:3072
    v_fma_f32 v28, v28, v161, v162
    v_fma_f32 v29, v29, v161, v162
    v_fma_f32 v30, v30, v161, v162
    v_fma_f32 v31, v31, v161, v162
    v_mul_f32 v24, v24, v172
    v_mul_f32 v25, v25, v173
    s_setprio 1
    s_waitcnt vmcnt(8) lgkmcnt(2)
    v_mfma_f32_32x32x16_bf16 v[112:127], v[76:79], v[12:15], v[112:127]
    ds_read_b128 v[8:11], v44 offset:5120
    v_mul_f32 v26, v26, v174
    v_mul_f32 v27, v27, v175
    v_mul_f32 v28, v28, v176
    v_mul_f32 v29, v29, v177
    v_mul_f32 v30, v30, v178
    v_mul_f32 v31, v31, v179
    s_waitcnt vmcnt(7) lgkmcnt(2)
    v_mfma_f32_32x32x16_bf16 v[128:143], v[80:83], v[16:19], v[128:143]
    ds_read_b128 v[12:15], v44 offset:7168
    v_exp_f32 v24, v24
    v_exp_f32 v25, v25
    v_exp_f32 v26, v26
    s_waitcnt vmcnt(6) lgkmcnt(2)
    v_mfma_f32_32x32x16_bf16 v[128:143], v[84:87], v[20:23], v[128:143]
    ds_read_b128 v[16:19], v44 offset:9216
    v_exp_f32 v27, v27
    v_exp_f32 v28, v28
    v_exp_f32 v29, v29
    ds_read_b32 v4, v46 offset:4096
    s_setprio 0
    s_waitcnt vmcnt(4) lgkmcnt(3)
    v_mfma_f32_32x32x16_bf16 v[128:143], v[88:91], v[8:11], v[128:143]
    ds_read_b128 v[20:23], v44 offset:11264
    v_exp_f32 v30, v30
    v_exp_f32 v31, v31
    v_fma_f32 v24, v24, v163, v163
    v_fma_f32 v25, v25, v163, v163
    v_cvt_pk_bf16_f32 v108, v112, v113
    v_cvt_pk_bf16_f32 v109, v114, v115
    v_cvt_pk_bf16_f32 v110, v116, v117
    v_cvt_pk_bf16_f32 v111, v118, v119
    v_and_b32 v108, -2, v108
    s_cmp_eq_u32 s61, 0
    s_cbranch_scc1 Lxs39
    buffer_store_dwordx4 v[108:111], v1, s[32:35], s14 offen offset:0
Lxb40:
    s_setprio 1
    s_waitcnt vmcnt(4) lgkmcnt(3)
    v_mfma_f32_32x32x16_bf16 v[128:143], v[92:95], v[12:15], v[128:143]
    ds_read_b128 v[8:11], v44 offset:13312
    s_waitcnt lgkmcnt(2)
    v_cmp_eq_u32 vcc, 0, v4
    v_fma_f32 v26, v26, v163, v163
    v_fma_f32 v27, v27, v163, v163
    v_fma_f32 v28, v28, v163, v163
    v_fma_f32 v29, v29, v163, v163
    v_fma_f32 v30, v30, v163, v163
    v_fma_f32 v31, v31, v163, v163
    s_cbranch_vccnz Lls41
Llb42:
    v_cvt_pk_bf16_f32 v196, v120, v121
    v_cvt_pk_bf16_f32 v197, v122, v123
    v_cvt_pk_bf16_f32 v198, v124, v125
    v_cvt_pk_bf16_f32 v199, v126, v127
    v_and_b32 v196, -2, v196
    s_cmp_eq_u32 s61, 0
    s_cbranch_scc1 Lxs43
    buffer_store_dwordx4 v[196:199], v1, s[32:35], s14 offen offset:1024
Lxb44:
    s_waitcnt vmcnt(4)
    v_mfma_f32_32x32x16_bf16 v[128:143], v[96:99], v[16:19], v[128:143]
    ds_read_b128 v[12:15], v44 offset:14336
    v_rcp_f32 v24, v24
    v_rcp_f32 v25, v25
    v_rcp_f32 v26, v26
    s_waitcnt vmcnt(3) lgkmcnt(2)
    v_mfma_f32_32x32x16_bf16 v[128:143], v[100:103], v[20:23], v[128:143]
    v_rcp_f32 v27, v27
    v_rcp_f32 v28, v28
    v_rcp_f32 v29, v29
    s_setprio 0
    s_waitcnt vmcnt(2) lgkmcnt(1)
    v_mfma_f32_32x32x16_bf16 v[128:143], v[104:107], v[8:11], v[128:143]
    ds_read_b128 v[16:19], v44 offset:16384
    v_rcp_f32 v30, v30
    v_rcp_f32 v31, v31
    v_mul_f32 v24, v24, v172
    v_mul_f32 v25, v25, v173
    s_setprio 1
    s_waitcnt lgkmcnt(1)
    v_mfma_f32_32x32x16_bf16 v[180:195], v[200:203], v[12:15], 0
    v_mul_f32 v26, v26, v174
    v_mul_f32 v27, v27, v175
    v_mul_f32 v28, v28, v176
    v_mul_f32 v29, v29, v177
    v_mul_f32 v30, v30, v178
    v_mul_f32 v31, v31, v179
    v_mfma_f32_32x32x16_bf16 v[144:159], v[204:207], v[12:15], 0
    ds_read_b128 v[20:23], v44 offset:18432
    v_cvt_pk_bf16_f32 v32, v24, v25
    v_cvt_pk_bf16_f32 v33, v26, v27
    v_cvt_pk_bf16_f32 v34, v28, v29
    v_cvt_pk_bf16_f32 v35, v30, v31
    ds_write_b128 v7, v[32:35] offset:15360
    ds_write_addtid_b32 v44 offset:59392
    s_waitcnt lgkmcnt(3)
    v_mfma_f32_32x32x16_bf16 v[180:195], v[208:211], v[16:19], v[180:195]
    v_cvt_pk_bf16_f32 v108, v128, v129
    v_cvt_pk_bf16_f32 v109, v130, v131
    v_cvt_pk_bf16_f32 v110, v132, v133
    v_cvt_pk_bf16_f32 v111, v134, v135
    v_and_b32 v108, -2, v108
    s_cmp_eq_u32 s61, 0
    s_cbranch_scc1 Lxs45
    buffer_store_dwordx4 v[108:111], v1, s[32:35], s12 offen offset:0
Lxb46:
    v_lshlrev_b32 v6, 3, v2
    global_load_dwordx2 v[6:7], v6, s[94:95] offset:-1536
    s_setprio 0
    v_mfma_f32_32x32x16_bf16 v[144:159], v[212:215], v[16:19], v[144:159]
    ds_read_b128 v[8:11], v44 offset:20480
    v_cvt_pk_bf16_f32 v196, v136, v137
    v_cvt_pk_bf16_f32 v197, v138, v139
    v_cvt_pk_bf16_f32 v198, v140, v141
    v_cvt_pk_bf16_f32 v199, v142, v143
    v_and_b32 v196, -2, v196
    s_cmp_eq_u32 s61, 0
    s_cbranch_scc1 Lxs47
    buffer_store_dwordx4 v[196:199], v1, s[32:35], s13 offen offset:0
Lxb48:
    s_setprio 1
    s_waitcnt lgkmcnt(3)
    v_mfma_f32_32x32x16_bf16 v[180:195], v[216:219], v[20:23], v[180:195]
    v_mfma_f32_32x32x16_bf16 v[144:159], v[220:223], v[20:23], v[144:159]
    ds_read_b128 v[12:15], v44 offset:22528
    v_mov_b32 v45, s56
    s_add_u32 s69, s18, 0
    s_waitcnt vmcnt(3)
    s_mov_b64 exec, 1
    s_cmp_eq_u32 s61, 0
    s_cbranch_scc1 Lxs49
    buffer_store_dword v45, off, s[32:35], s69
Lxb50:
    s_mov_b64 exec, -1
    s_waitcnt lgkmcnt(1)
    v_mfma_f32_32x32x16_bf16 v[180:195], v[224:227], v[8:11], v[180:195]
    s_setprio 0
    v_mfma_f32_32x32x16_bf16 v[144:159], v[228:231], v[8:11], v[144:159]
    ds_read_b128 v[16:19], v44 offset:24576
    s_setprio 1
    s_waitcnt lgkmcnt(1)
    v_mfma_f32_32x32x16_bf16 v[180:195], v[232:235], v[12:15], v[180:195]
    ds_read_b32 v4, v46 offset:6144
    v_mfma_f32_32x32x16_bf16 v[144:159], v[236:239], v[12:15], v[144:159]
    ds_read_b128 v[20:23], v44 offset:26624
    s_waitcnt lgkmcnt(2)
    v_mfma_f32_32x32x16_bf16 v[180:195], v[240:243], v[16:19], v[180:195]
    s_waitcnt lgkmcnt(1)
    v_cmp_eq_u32 vcc, 0, v4
    s_nop 1
    s_cbranch_vccnz Lls51
Llb52:
    s_add_u32 s70, s19, 0
    buffer_load_dword v47, off, s[32:35], s70 sc1
    s_setprio 0
    v_mfma_f32_32x32x16_bf16 v[144:159], v[244:247], v[16:19], v[144:159]
    ds_read_b128 v[8:11], v44 offset:15360
    buffer_load_dwordx4 v[172:175], v1, s[32:35], s15 offen offset:0 sc1
    buffer_load_dwordx4 v[176:179], v1, s[32:35], s16 offen offset:0 sc1
    s_setprio 1
    s_waitcnt lgkmcnt(1)
    v_mfma_f32_32x32x16_bf16 v[180:195], v[248:251], v[20:23], v[180:195]
    ds_read_b128 v[12:15], v44 offset:17408
    v_mov_b32 v45, s56
    s_add_u32 s69, s18, 8192
    s_waitcnt vmcnt(4)
    s_mov_b64 exec, 1
    s_cmp_eq_u32 s61, 0
    s_cbranch_scc1 Lxs53
    buffer_store_dword v45, off, s[32:35], s69
Lxb54:
    s_mov_b64 exec, -1
    v_mfma_f32_32x32x16_bf16 v[144:159], v[252:255], v[20:23], v[144:159]
    ds_read_b128 v[16:19], v44 offset:19456
    s_waitcnt lgkmcnt(2)
    v_mfma_f32_32x32x16_bf16 v[144:159], v[80:83], v[8:11], v[144:159]
    ds_read_b128 v[20:23], v44 offset:21504
    s_setprio 0
    s_waitcnt lgkmcnt(2)
    v_mfma_f32_32x32x16_bf16 v[144:159], v[84:87], v[12:15], v[144:159]
    ds_read_b128 v[8:11], v44 offset:23552
    s_setprio 1
    s_waitcnt lgkmcnt(2)
    v_mfma_f32_32x32x16_bf16 v[144:159], v[88:91], v[16:19], v[144:159]
    ds_read_b128 v[12:15], v44 offset:25600
    s_waitcnt vmcnt(3)
    v_subrev_u32 v47, s56, v47
    v_cmp_lt_u32 vcc, 15, v47
    s_mov_b32 s97, 0
    s_nop 0
    s_cbranch_vccnz Lpr55
Lpb56:
    buffer_load_dwordx4 v[164:167], v1, s[32:35], s17 offen offset:0 sc1
    buffer_load_dwordx4 v[168:171], v1, s[32:35], s17 offen offset:1024 sc1
    s_waitcnt lgkmcnt(2)
    v_mfma_f32_32x32x16_bf16 v[144:159], v[92:95], v[20:23], v[144:159]
    ds_read_b128 v[16:19], v44 offset:27648
    s_waitcnt lgkmcnt(2)
    v_mfma_f32_32x32x16_bf16 v[144:159], v[96:99], v[8:11], v[144:159]
    ds_read_b128 v[20:23], v44 offset:15360
    s_setprio 0
    s_waitcnt lgkmcnt(2)
    v_mfma_f32_32x32x16_bf16 v[144:159], v[100:103], v[12:15], v[144:159]
    ds_read_b128 v[8:11], v44 offset:17408
    s_waitcnt vmcnt(3)
    v_or_b32 v4, v172, v176
    v_and_b32 v4, 1, v4
    v_cmp_eq_u32 vcc, 1, v4
    s_mov_b32 s97, 0
    s_nop 0
    s_cbranch_vccnz Lsr57
Lsb58:
    v_lshlrev_b32 v128, 16, v172
    v_and_b32 v129, 0xffff0000, v172
    v_lshlrev_b32 v130, 16, v173
    v_and_b32 v131, 0xffff0000, v173
    buffer_load_dword v45, v7, s[32:35], s72 offen sc1
    s_setprio 1
    s_waitcnt lgkmcnt(2)
    v_mfma_f32_32x32x16_bf16 v[144:159], v[104:107], v[16:19], v[144:159]
    ds_read_b128 v[12:15], v44 offset:19456
    v_lshlrev_b32 v132, 16, v174
    v_and_b32 v133, 0xffff0000, v174
    v_lshlrev_b32 v134, 16, v175
    v_and_b32 v135, 0xffff0000, v175
    s_waitcnt lgkmcnt(2)
    v_mfma_f32_32x32x16_bf16 v[180:195], v[52:55], v[20:23], v[180:195]
    ds_read_b128 v[16:19], v44 offset:21504
    v_lshlrev_b32 v136, 16, v176
    v_and_b32 v137, 0xffff0000, v176
    v_lshlrev_b32 v138, 16, v177
    v_and_b32 v139, 0xffff0000, v177
    s_waitcnt lgkmcnt(2)
    v_mfma_f32_32x32x16_bf16 v[180:195], v[56:59], v[8:11], v[180:195]
    ds_read_b128 v[20:23], v44 offset:23552
    v_lshlrev_b32 v140, 16, v178
    v_and_b32 v141, 0xffff0000, v178
    v_lshlrev_b32 v142, 16, v179
    v_and_b32 v143, 0xffff0000, v179
    s_setprio 0
    s_waitcnt lgkmcnt(2)
    v_mfma_f32_32x32x16_bf16 v[180:195], v[60:63], v[12:15], v[180:195]
    ds_read_b128 v[8:11], v44 offset:25600
    v_add_f32 v144, v144, v128
    v_add_f32 v145, v145, v129
    v_add_f32 v146, v146, v130
    v_add_f32 v147, v147, v131
    v_add_f32 v148, v148, v132
    v_add_f32 v149, v149, v133
    v_add_f32 v150, v150, v134
    v_add_f32 v151, v151, v135
    v_cvt_pk_bf16_f32 v108, v144, v145
    v_cvt_pk_bf16_f32 v109, v146, v147
    v_cvt_pk_bf16_f32 v110, v148, v149
    v_cvt_pk_bf16_f32 v111, v150, v151
    v_or_b32 v108, 1, v108
    s_cmp_eq_u32 s61, 0
    s_cbranch_scc1 Lxs59
    buffer_store_dwordx4 v[108:111], v1, s[32:35], s15 offen offset:0
Lxb60:
    s_setprio 1
    s_waitcnt lgkmcnt(2)
    v_mfma_f32_32x32x16_bf16 v[180:195], v[64:67], v[16:19], v[180:195]
    ds_read_b128 v[12:15], v44 offset:27648
    s_waitcnt vmcnt(3)
    v_lshlrev_b32 v112, 16, v164
    v_and_b32 v113, 0xffff0000, v164
    v_lshlrev_b32 v114, 16, v165
    v_and_b32 v115, 0xffff0000, v165
    s_waitcnt lgkmcnt(2)
    v_mfma_f32_32x32x16_bf16 v[180:195], v[68:71], v[20:23], v[180:195]
    v_lshlrev_b32 v116, 16, v166
    v_and_b32 v117, 0xffff0000, v166
    v_lshlrev_b32 v118, 16, v167
    v_and_b32 v119, 0xffff0000, v167
    v_add_f32 v152, v152, v136
    v_add_f32 v153, v153, v137
    v_add_f32 v154, v154, v138
    v_add_f32 v155, v155, v139
    v_add_f32 v156, v156, v140
    v_add_f32 v157, v157, v141
    v_add_f32 v158, v158, v142
    v_add_f32 v159, v159, v143
    v_cvt_pk_bf16_f32 v196, v152, v153
    v_cvt_pk_bf16_f32 v197, v154, v155
    v_cvt_pk_bf16_f32 v198, v156, v157
    v_cvt_pk_bf16_f32 v199, v158, v159
    v_or_b32 v196, 1, v196
    s_cmp_eq_u32 s61, 0
    s_cbranch_scc1 Lxs61
    buffer_store_dwordx4 v[196:199], v1, s[32:35], s16 offen offset:0
Lxb62:
    s_waitcnt lgkmcnt(1)
    v_mfma_f32_32x32x16_bf16 v[180:195], v[72:75], v[8:11], v[180:195]
    s_waitcnt vmcnt(3)
    v_lshlrev_b32 v120, 16, v168
    v_and_b32 v121, 0xffff0000, v168
    v_lshlrev_b32 v122, 16, v169
    v_and_b32 v123, 0xffff0000, v169
    s_setprio 0
    s_waitcnt lgkmcnt(0)
    v_mfma_f32_32x32x16_bf16 v[180:195], v[76:79], v[12:15], v[180:195]
    v_lshlrev_b32 v124, 16, v170
    v_and_b32 v125, 0xffff0000, v170
    v_lshlrev_b32 v126, 16, v171
    v_and_b32 v127, 0xffff0000, v171
    s_waitcnt vmcnt(2)
    v_subrev_u32 v45, s56, v45
    v_cmp_lt_u32 vcc, 15, v45
    s_mov_b32 s97, 0
    s_nop 0
    s_cbranch_vccnz Lpr63
Lpb64:
    s_nop 1
    v_pk_add_f32 v[180:181], v[180:181], v[112:113]
    v_pk_add_f32 v[182:183], v[182:183], v[114:115]
    v_pk_add_f32 v[184:185], v[184:185], v[116:117]
    v_pk_add_f32 v[186:187], v[186:187], v[118:119]
    v_cvt_pk_bf16_f32 v24, v180, v181
    v_cvt_pk_bf16_f32 v25, v182, v183
    v_cvt_pk_bf16_f32 v26, v184, v185
    v_cvt_pk_bf16_f32 v27, v186, v187
    v_or_b32 v24, 1, v24
    s_cmp_eq_u32 s61, 0
    s_cbranch_scc1 Lxs65
    buffer_store_dwordx4 v[24:27], v1, s[32:35], s17 offen offset:0
Lxb66:
    v_pk_add_f32 v[188:189], v[188:189], v[120:121]
    v_pk_add_f32 v[190:191], v[190:191], v[122:123]
    v_pk_add_f32 v[192:193], v[192:193], v[124:125]
    v_pk_add_f32 v[194:195], v[194:195], v[126:127]
    v_cvt_pk_bf16_f32 v28, v188, v189
    v_cvt_pk_bf16_f32 v29, v190, v191
    v_cvt_pk_bf16_f32 v30, v192, v193
    v_cvt_pk_bf16_f32 v31, v194, v195
    v_or_b32 v28, 1, v28
    s_cmp_eq_u32 s61, 0
    s_cbranch_scc1 Lxs67
    buffer_store_dwordx4 v[28:31], v1, s[32:35], s17 offen offset:1024
Lxb68:
    s_waitcnt vmcnt(0)
    buffer_load_dwordx4 v[52:55], v5, s[32:35], s74 offen offset:0 sc1
    buffer_load_dwordx4 v[56:59], v5, s[32:35], s74 offen offset:256 sc1
    buffer_load_dwordx4 v[60:63], v5, s[32:35], s75 offen offset:0 sc1
    buffer_load_dwordx4 v[64:67], v5, s[32:35], s75 offen offset:256 sc1
    s_waitcnt vmcnt(2)
    v_and_b32 v8, v52, v56
    s_waitcnt vmcnt(0)
    v_and_b32 v9, v60, v64
    v_and_b32 v8, 1, v8
    v_and_b32 v8, v8, v9
    v_cmp_eq_u32 vcc, 0, v8
    s_mov_b32 s97, 0
    s_nop 0
    s_cbranch_vccnz Ler69
Leb70:
    v_mfma_f32_16x16x32_bf16 v[36:39], v[48:51], v[52:55], v[36:39]
    v_mfma_f32_16x16x32_bf16 v[40:43], v[48:51], v[56:59], v[40:43]
    v_mfma_f32_16x16x32_bf16 v[36:39], v[48:51], v[60:63], v[36:39]
    v_mfma_f32_16x16x32_bf16 v[40:43], v[48:51], v[64:67], v[40:43]
    s_nop 6
    v_cvt_pk_bf16_f32 v20, v36, v37
    v_cvt_pk_bf16_f32 v21, v38, v39
    v_cvt_pk_bf16_f32 v22, v40, v41
    v_cvt_pk_bf16_f32 v23, v42, v43
    s_nop 0
    v_permlane16_swap_b32 v20, v22
    v_permlane16_swap_b32 v21, v23
    buffer_store_dwordx4 v[20:23], v6, s[36:39], s76 offen
    s_endpgm
Lsw:
    s_setprio 2
    s_and_b32 s70, s2, 0xc7
    s_lshl_b32 s70, s70, 4
    s_mul_i32 s71, s53, 4352
    s_add_u32 s70, s70, s71
    s_add_u32 s70, s70, 33751040
    v_and_b32 v44, 7, v2
    v_lshlrev_b32 v44, 7, v44
    buffer_load_dword v48, v44, s[32:35], s70 offen sc1
    s_and_b32 s70, s58, 1
    s_mul_i32 s71, s70, 9
    s_lshl3_add_u32 s71, s57, s71
    s_sub_u32 s71, s71, 1
    s_max_i32 s71, s71, 0
    s_min_i32 s71, s71, 511
    s_lshr_b32 s88, s71, 3
    s_mul_i32 s88, s88, 28672
    s_and_b32 s71, s71, 7
    s_lshl4_add_u32 s88, s71, s88
    s_add_u32 s88, s88, 12582912
    s_mul_i32 s70, s70, 384
    s_add_u32 s70, s70, 107008
    v_min_u32 v5, 55, v2
    v_lshlrev_b32 v4, 9, v5
    v_mul_u32_u24 v5, 768, v5
    v_add_u32 v5, s70, v5
    s_waitcnt vmcnt(1)
    s_cmp_lt_u32 s54, 28
    s_cbranch_scc1 Lc71
    s_lshl_b32 s68, s2, 6
    s_add_u32 s68, s68, 33658880
    v_mov_b32 v9, 0
    s_mov_b32 exec_lo, 1
    s_mov_b32 exec_hi, 0
    buffer_load_dword v8, v9, s[32:35], s68 offen sc1
    s_waitcnt vmcnt(0)
    v_subrev_u32 v8, s56, v8
    v_cmp_lt_u32 vcc, 15, v8
    s_mov_b32 s97, 0
    s_nop 0
    s_cbranch_vccnz Lpr72
Lpb73:
    s_mov_b64 exec, -1
    s_nop 0
Lc71:
    buffer_load_dwordx4 v[8:11], v4, s[32:35], s88 offen offset:0 sc1
    buffer_load_dwordx4 v[12:15], v4, s[32:35], s88 offen offset:128 sc1
    buffer_load_dwordx4 v[16:19], v4, s[32:35], s88 offen offset:256 sc1
    buffer_load_dwordx4 v[20:23], v4, s[32:35], s88 offen offset:384 sc1
    buffer_load_dword v25, v26, s[32:35], 0 offen sc1
    v_mov_b32 v52, 0x3f803f80
    v_mov_b32 v53, 0x3f803f80
    v_mov_b32 v54, 0x3f803f80
    v_mov_b32 v55, 0x3f803f80
    v_mov_b32 v56, 0x3f803f80
    v_mov_b32 v57, 0x3f803f80
    v_mov_b32 v58, 0x3f803f80
    v_mov_b32 v59, 0x3f803f80
    v_mov_b32 v60, 0x3f803f80
    v_mov_b32 v61, 0x3f803f80
    v_mov_b32 v62, 0x3f803f80
    v_mov_b32 v63, 0x3f803f80
    v_mov_b32 v64, 0x3f803f80
    v_mov_b32 v65, 0x3f803f80
    v_mov_b32 v66, 0x3f803f80
    v_mov_b32 v67, 0x3f803f80
    v_mov_b32 v68, 0x3f803f80
    v_mov_b32 v69, 0x3f803f80
    v_mov_b32 v70, 0x3f803f80
    v_mov_b32 v71, 0x3f803f80
    v_mov_b32 v72, 0x3f803f80
    v_mov_b32 v73, 0x3f803f80
    v_mov_b32 v74, 0x3f803f80
    v_mov_b32 v75, 0x3f803f80
    v_mov_b32 v76, 0x3f803f80
    v_mov_b32 v77, 0x3f803f80
    v_mov_b32 v78, 0x3f803f80
    v_mov_b32 v79, 0x3f803f80
    v_mov_b32 v80, 0x3f803f80
    v_mov_b32 v81, 0x3f803f80
    v_mov_b32 v82, 0x3f803f80
    v_mov_b32 v83, 0x3f803f80
    v_and_b32 v44, 3, v2
    v_bfe_u32 v45, v2, 2, 2
    v_mad_u32_u24 v40, v45, 3, v44
    v_lshrrev_b32 v41, 4, v2
    v_add_u32 v46, 0, v40
    v_and_b32 v47, 3, v46
    v_lshlrev_b32 v47, 2, v47
    v_and_or_b32 v47, v46, -16, v47
    v_bfe_u32 v84, v46, 2, 2
    v_or_b32 v84, v84, v47
    v_lshlrev_b32 v84, 4, v84
    v_mul_u32_u24 v47, 768, v41
    v_add_u32 v84, v84, v47
    v_add_u32 v84, 106880, v84
    v_add_u32 v46, 12, v40
    v_and_b32 v47, 3, v46
    v_lshlrev_b32 v47, 2, v47
    v_and_or_b32 v47, v46, -16, v47
    v_bfe_u32 v85, v46, 2, 2
    v_or_b32 v85, v85, v47
    v_lshlrev_b32 v85, 4, v85
    v_mul_u32_u24 v47, 768, v41
    v_add_u32 v85, v85, v47
    v_add_u32 v85, 106880, v85
    v_add_u32 v46, 24, v40
    v_and_b32 v47, 3, v46
    v_lshlrev_b32 v47, 2, v47
    v_and_or_b32 v47, v46, -16, v47
    v_bfe_u32 v86, v46, 2, 2
    v_or_b32 v86, v86, v47
    v_lshlrev_b32 v86, 4, v86
    v_mul_u32_u24 v47, 768, v41
    v_add_u32 v86, v86, v47
    v_add_u32 v86, 106880, v86
    v_sub_u32 v45, v45, v41
    v_and_b32 v45, 3, v45
    v_cmp_eq_u32 s[78:79], 1, v45
    v_cmp_eq_u32 s[80:81], 2, v45
    v_mad_u32_u24 v40, v41, 3, v44
    v_mad_u32_u24 v40, v45, 12, v40
    v_lshlrev_b32 v42, 4, v40
    v_add_u32 v42, 149888, v42
    v_lshlrev_b32 v43, 3, v40
    v_add_u32 v43, 150656, v43
    v_lshlrev_b32 v6, 2, v2
    v_lshlrev_b32 v7, 7, v2
    s_waitcnt vmcnt(5)
    v_cmp_ne_u32 vcc, s83, v48
    v_mov_b32 v46, 151040
    s_nop 0
    s_cmp_eq_u64 vcc, 0
    s_cselect_b32 s61, 1, 0
    v_mov_b32 v45, s61
    ds_write_b32 v46, v45
    v_and_b32 v38, 7, v2
    v_mul_u32_u24 v38, 260, v38
    v_add_u32 v38, 86016, v38
    v_lshlrev_b32 v46, 8, v2
    v_and_b32 v46, 0x3800, v46
    v_add_u32 v46, v46, v38
    s_mov_b32 vcc_lo, 0x80800080
    s_mov_b32 vcc_hi, 0x8000807f
    v_cndmask_b32 v45, 0, v38, vcc
    ds_write_b32 v46, v45
    s_waitcnt vmcnt(2)
    v_or3_b32 v24, v8, v12, v16
    s_waitcnt vmcnt(1)
    v_or_b32 v24, v24, v20
    v_and_b32 v24, 1, v24
    v_cmp_eq_u32 vcc, 1, v24
    s_mov_b32 s97, 0
    s_nop 0
    s_cbranch_vccnz Lhr74
Lhb75:
    s_bitcmp1_b32 s58, 0
    s_cselect_b64 vcc, -1, 0
    v_cndmask_b32 v28, v10, v8, vcc
    v_cndmask_b32 v29, v14, v12, vcc
    v_cndmask_b32 v30, v18, v16, vcc
    v_cndmask_b32 v31, v22, v20, vcc
    ds_write_b128 v5, v[28:31] offset:0
    v_cndmask_b32 v32, v11, v9, vcc
    v_cndmask_b32 v33, v15, v13, vcc
    v_cndmask_b32 v34, v19, v17, vcc
    v_cndmask_b32 v35, v23, v21, vcc
    ds_write_b128 v5, v[32:35] offset:64
    s_waitcnt vmcnt(0)
    v_subrev_u32 v25, s56, v25
    v_cmp_lt_u32 vcc, 15, v25
    s_mov_b32 s97, 0
    s_nop 0
    s_cbranch_vccnz Lpr76
Lpb77:
    s_lshl_b32 s72, s57, 7
    s_add_u32 s72, s72, 33570816
    s_lshl2_add_u32 s4, s57, s58
    s_lshl_b32 s4, s4, 9
    s_add_u32 s4, s4, 7864320
    s_mov_b32 m0, 151168
    v_min_u32 v45, 2, v2
    v_lshlrev_b32 v45, 13, v45
    v_and_b32 v47, 0x180, v7
    buffer_load_dword v45, s[32:35], s72 offen sc1 lds
    buffer_load_dword v47, s[32:35], s4 offen sc1 lds
    v_cmp_eq_u32 s[92:93], 1, v44
    v_cmp_eq_u32 s[94:95], 2, v44
    s_mov_b32 s96, 991054117
    v_mov_b32 v49, 0x3f800054
    s_lshl2_add_u32 s70, s57, s58
    s_lshl_b32 s71, s70, 4
    s_add_u32 s71, s71, 33677312
    v_and_b32 v45, 1, v2
    v_lshlrev_b32 v45, 3, v45
    v_sub_u32 v45, v44, v45
    s_lshl2_add_u32 s72, s57, 4
    v_add_u32 v45, s72, v45
    v_mov_b32 v47, s70
    v_cmp_gt_u32 vcc, 0x100, v45
    v_mov_b32 v36, s56
    s_mov_b32 s72, 33677312
    v_cndmask_b32 v45, v47, v45, vcc
    s_xor_b32 s70, s70, 4
    v_writelane_b32 v45, s70, 4
    v_lshlrev_b32 v37, 4, v45
    s_waitcnt lgkmcnt(0)
    s_barrier
    s_mov_b64 exec, 1
    buffer_store_dword v36, off, s[32:35], s71 sc1
    s_mov_b32 exec_lo, 0x77777777
    s_mov_b32 exec_hi, 0x77777777
    ds_read_b128 v[52:55], v84 offset:0
    ds_read_b128 v[56:59], v85 offset:0
    ds_read_b128 v[60:63], v86 offset:0
    ds_read_b128 v[64:67], v84 offset:3072
    ds_read_b128 v[68:71], v85 offset:3072
    ds_read_b128 v[72:75], v86 offset:3072
    ds_read_b128 v[76:79], v84 offset:6144
    ds_read_b128 v[80:83], v85 offset:6144
    s_waitcnt lgkmcnt(7)
    v_mfma_f32_16x16x32_bf16 v[24:27], v[52:55], v[52:55], 0
    ds_read_b128 v[52:55], v86 offset:6144
    s_waitcnt lgkmcnt(7)
    v_mfma_f32_16x16x32_bf16 v[28:31], v[56:59], v[56:59], 0
    ds_read_b128 v[56:59], v84 offset:9216
    s_waitcnt lgkmcnt(7)
    v_mfma_f32_16x16x32_bf16 v[32:35], v[60:63], v[60:63], 0
    ds_read_b128 v[60:63], v85 offset:9216
    s_waitcnt lgkmcnt(7)
    v_mfma_f32_16x16x32_bf16 v[24:27], v[64:67], v[64:67], v[24:27]
    ds_read_b128 v[64:67], v86 offset:9216
    s_waitcnt lgkmcnt(7)
    v_mfma_f32_16x16x32_bf16 v[28:31], v[68:71], v[68:71], v[28:31]
    ds_read_b128 v[68:71], v84 offset:12288
    s_waitcnt lgkmcnt(7)
    v_mfma_f32_16x16x32_bf16 v[32:35], v[72:75], v[72:75], v[32:35]
    ds_read_b128 v[72:75], v85 offset:12288
    s_waitcnt lgkmcnt(7)
    v_mfma_f32_16x16x32_bf16 v[24:27], v[76:79], v[76:79], v[24:27]
    ds_read_b128 v[76:79], v86 offset:12288
    s_waitcnt lgkmcnt(7)
    v_mfma_f32_16x16x32_bf16 v[28:31], v[80:83], v[80:83], v[28:31]
    ds_read_b128 v[80:83], v84 offset:15360
    s_waitcnt lgkmcnt(7)
    v_mfma_f32_16x16x32_bf16 v[32:35], v[52:55], v[52:55], v[32:35]
    ds_read_b128 v[52:55], v85 offset:15360
    s_waitcnt lgkmcnt(7)
    v_mfma_f32_16x16x32_bf16 v[24:27], v[56:59], v[56:59], v[24:27]
    ds_read_b128 v[56:59], v86 offset:15360
    s_waitcnt lgkmcnt(7)
    v_mfma_f32_16x16x32_bf16 v[28:31], v[60:63], v[60:63], v[28:31]
    ds_read_b128 v[60:63], v84 offset:18432
    s_waitcnt lgkmcnt(7)
    v_mfma_f32_16x16x32_bf16 v[32:35], v[64:67], v[64:67], v[32:35]
    ds_read_b128 v[64:67], v85 offset:18432
    s_waitcnt lgkmcnt(7)
    v_mfma_f32_16x16x32_bf16 v[24:27], v[68:71], v[68:71], v[24:27]
    ds_read_b128 v[68:71], v86 offset:18432
    s_waitcnt lgkmcnt(7)
    v_mfma_f32_16x16x32_bf16 v[28:31], v[72:75], v[72:75], v[28:31]
    ds_read_b128 v[72:75], v84 offset:21504
    s_waitcnt lgkmcnt(7)
    v_mfma_f32_16x16x32_bf16 v[32:35], v[76:79], v[76:79], v[32:35]
    ds_read_b128 v[76:79], v85 offset:21504
    s_waitcnt lgkmcnt(7)
    v_mfma_f32_16x16x32_bf16 v[24:27], v[80:83], v[80:83], v[24:27]
    ds_read_b128 v[80:83], v86 offset:21504
    s_waitcnt lgkmcnt(7)
    v_mfma_f32_16x16x32_bf16 v[28:31], v[52:55], v[52:55], v[28:31]
    ds_read_b128 v[52:55], v84 offset:24576
    s_waitcnt lgkmcnt(7)
    v_mfma_f32_16x16x32_bf16 v[32:35], v[56:59], v[56:59], v[32:35]
    ds_read_b128 v[56:59], v85 offset:24576
    s_waitcnt lgkmcnt(7)
    v_mfma_f32_16x16x32_bf16 v[24:27], v[60:63], v[60:63], v[24:27]
    ds_read_b128 v[60:63], v86 offset:24576
    s_waitcnt lgkmcnt(7)
    v_mfma_f32_16x16x32_bf16 v[28:31], v[64:67], v[64:67], v[28:31]
    ds_read_b128 v[64:67], v84 offset:27648
    s_waitcnt lgkmcnt(7)
    v_mfma_f32_16x16x32_bf16 v[32:35], v[68:71], v[68:71], v[32:35]
    ds_read_b128 v[68:71], v85 offset:27648
    s_waitcnt lgkmcnt(7)
    v_mfma_f32_16x16x32_bf16 v[24:27], v[72:75], v[72:75], v[24:27]
    ds_read_b128 v[72:75], v86 offset:27648
    s_waitcnt lgkmcnt(7)
    v_mfma_f32_16x16x32_bf16 v[28:31], v[76:79], v[76:79], v[28:31]
    ds_read_b128 v[76:79], v84 offset:30720
    s_waitcnt lgkmcnt(7)
    v_mfma_f32_16x16x32_bf16 v[32:35], v[80:83], v[80:83], v[32:35]
    ds_read_b128 v[80:83], v85 offset:30720
    s_waitcnt lgkmcnt(7)
    v_mfma_f32_16x16x32_bf16 v[24:27], v[52:55], v[52:55], v[24:27]
    ds_read_b128 v[52:55], v86 offset:30720
    s_waitcnt lgkmcnt(7)
    v_mfma_f32_16x16x32_bf16 v[28:31], v[56:59], v[56:59], v[28:31]
    ds_read_b128 v[56:59], v84 offset:33792
    s_waitcnt lgkmcnt(7)
    v_mfma_f32_16x16x32_bf16 v[32:35], v[60:63], v[60:63], v[32:35]
    ds_read_b128 v[60:63], v85 offset:33792
    s_waitcnt lgkmcnt(7)
    v_mfma_f32_16x16x32_bf16 v[24:27], v[64:67], v[64:67], v[24:27]
    ds_read_b128 v[64:67], v86 offset:33792
    s_waitcnt lgkmcnt(7)
    v_mfma_f32_16x16x32_bf16 v[28:31], v[68:71], v[68:71], v[28:31]
    ds_read_b128 v[68:71], v84 offset:36864
    s_waitcnt lgkmcnt(7)
    v_mfma_f32_16x16x32_bf16 v[32:35], v[72:75], v[72:75], v[32:35]
    ds_read_b128 v[72:75], v85 offset:36864
    s_waitcnt lgkmcnt(7)
    v_mfma_f32_16x16x32_bf16 v[24:27], v[76:79], v[76:79], v[24:27]
    ds_read_b128 v[76:79], v86 offset:36864
    s_waitcnt lgkmcnt(7)
    v_mfma_f32_16x16x32_bf16 v[28:31], v[80:83], v[80:83], v[28:31]
    ds_read_b128 v[80:83], v84 offset:39936
    s_waitcnt lgkmcnt(7)
    v_mfma_f32_16x16x32_bf16 v[32:35], v[52:55], v[52:55], v[32:35]
    ds_read_b128 v[52:55], v85 offset:39936
    s_waitcnt lgkmcnt(7)
    v_mfma_f32_16x16x32_bf16 v[24:27], v[56:59], v[56:59], v[24:27]
    ds_read_b128 v[56:59], v86 offset:39936
    s_waitcnt lgkmcnt(7)
    v_mfma_f32_16x16x32_bf16 v[28:31], v[60:63], v[60:63], v[28:31]
    s_waitcnt lgkmcnt(6)
    v_mfma_f32_16x16x32_bf16 v[32:35], v[64:67], v[64:67], v[32:35]
    s_waitcnt lgkmcnt(5)
    v_mfma_f32_16x16x32_bf16 v[24:27], v[68:71], v[68:71], v[24:27]
    s_waitcnt lgkmcnt(4)
    v_mfma_f32_16x16x32_bf16 v[28:31], v[72:75], v[72:75], v[28:31]
    s_waitcnt lgkmcnt(3)
    v_mfma_f32_16x16x32_bf16 v[32:35], v[76:79], v[76:79], v[32:35]
    s_waitcnt lgkmcnt(2)
    v_mfma_f32_16x16x32_bf16 v[24:27], v[80:83], v[80:83], v[24:27]
    s_waitcnt lgkmcnt(1)
    v_mfma_f32_16x16x32_bf16 v[28:31], v[52:55], v[52:55], v[28:31]
    s_waitcnt lgkmcnt(0)
    v_mfma_f32_16x16x32_bf16 v[32:35], v[56:59], v[56:59], v[32:35]
    s_mov_b64 exec, -1
    s_nop 2
    v_cndmask_b32 v24, v24, v25, s[92:93]
    s_nop 0
    v_cndmask_b32 v28, v28, v29, s[92:93]
    s_nop 0
    v_cndmask_b32 v32, v32, v33, s[92:93]
    v_cndmask_b32 v24, v24, v26, s[94:95]
    v_cndmask_b32 v28, v28, v30, s[94:95]
    v_cndmask_b32 v32, v32, v34, s[94:95]
    v_mov_b32_dpp v29, v31 row_ror:4
    v_mov_b32_dpp v30, v28 row_ror:4
    v_mov_b32_dpp v33, v35 row_ror:8
    v_mov_b32_dpp v34, v32 row_ror:8
    v_cndmask_b32 v27, v27, v29, s[78:79]
    v_cndmask_b32 v24, v24, v30, s[78:79]
    v_cndmask_b32 v27, v27, v33, s[80:81]
    v_cndmask_b32 v24, v24, v34, s[80:81]
    s_mov_b32 exec_lo, 0x77700777
    s_mov_b32 exec_hi, 0x70777707
    v_mul_f32 v27, s96, v27
    v_mul_f32 v24, s96, v24
    v_fma_f32 v24, -v27, v27, v24
    v_max_f32 v24, 0, v24
    v_fmaak_f32 v26, v24, v49, 0x2edbe6ff
    v_add_f32 v51, 925353388, v24
    v_rsq_f32 v25, v26
    v_rsq_f32 v51, v51
    v_mul_f32 v24, 0xc0135761, v25
    v_mul_f32 v28, 0x3d372713, v25
    v_mul_f32 v26, v26, v25
    v_mul_f32 v25, v25, v24
    v_mul_f32 v50, -v27, v51
    v_mul_f32 v25, v25, v28
    ds_write_b64 v43, v[50:51] offset:0
    ds_write_b128 v42, v[24:27] offset:0
    s_waitcnt lgkmcnt(0)
    s_mov_b64 exec, 0x80
    ds_write_b32 v38, v38 offset:12288
    s_mov_b64 exec, -1
    s_mov_b32 exec_lo, 31
    s_mov_b32 exec_hi, 0
    buffer_load_dword v4, v37, s[32:35], s72 offen sc1
    s_waitcnt vmcnt(0)
    v_subrev_u32 v4, s56, v4
    v_cmp_lt_u32 vcc, 15, v4
    s_mov_b32 s97, 0
    s_nop 0
    s_cbranch_vccnz Lpr78
Lpb79:
    s_mov_b64 exec, -1
    v_lshlrev_b32 v39, 3, v2
    v_add_u32 v39, 102400, v39
    v_and_b32 v40, 0x1f0, v1
    v_lshrrev_b32 v41, 5, v2
    v_lshl_add_u32 v42, v41, 10, v40
    v_add_u32 v42, 151424, v42
    v_xor_b32 v41, s57, v41
    v_xor_b32 v41, 1, v41
    v_lshl_add_u32 v40, v41, 11, v40
    v_mov_b32 v10, s56
    v_mov_b32 v11, s56
    s_mov_b32 s5, 7864320
    s_barrier
    s_mov_b32 s97, 0
    s_branch Ltx81
Ltw80:
    s_sleep 1
    s_add_u32 s97, s97, 1
    s_cmp_gt_u32 s97, 2097152
    s_cbranch_scc1 Lty82
Ltx81:
    ds_read_b32 v4, v38 offset:14336
    s_waitcnt lgkmcnt(0)
    v_cmp_eq_u32 vcc, 0, v4
    s_nop 1
    s_cbranch_vccnz Ltw80
Lty82:
    ds_read_b64 v[12:13], v39 offset:0
    ds_read_b64 v[14:15], v39 offset:512
    ds_read_b64 v[16:17], v39 offset:1024
    ds_read_b64 v[18:19], v39 offset:1536
    ds_read_b64 v[20:21], v39 offset:2048
    ds_read_b64 v[22:23], v39 offset:2560
    ds_read_b64 v[24:25], v39 offset:3072
    s_waitcnt lgkmcnt(5)
    v_add_f32 v12, v12, v14
    s_waitcnt lgkmcnt(3)
    v_add_f32 v16, v16, v18
    v_add_f32 v13, v13, v15
    v_add_f32 v17, v17, v19
    s_waitcnt lgkmcnt(1)
    v_add_f32 v20, v20, v22
    v_add_f32 v12, v12, v16
    v_add_f32 v21, v21, v23
    v_add_f32 v13, v13, v17
    s_waitcnt lgkmcnt(0)
    v_add_f32 v20, v20, v24
    v_add_f32 v21, v21, v25
    v_add_f32 v8, v12, v20
    v_add_f32 v12, v12, v20
    v_add_f32 v9, v13, v21
    v_add_f32 v13, v13, v21
    v_permlane32_swap_b32 v8, v12
    s_nop 0
    v_permlane32_swap_b32 v9, v13
    v_add_f32 v8, v8, v12
    v_add_f32 v9, v9, v13
    s_mov_b32 exec_hi, 0
    s_cmp_eq_u32 s61, 0
    s_cbranch_scc1 Lxs83
    buffer_store_dwordx4 v[8:11], v1, s[32:35], s4 offen
Lxb84:
    s_mov_b32 exec_hi, -1
    s_barrier
    buffer_load_dwordx4 v[52:55], v40, s[32:35], s5 offen offset:0 sc1
    buffer_load_dwordx4 v[56:59], v40, s[32:35], s5 offen offset:512 sc1
    buffer_load_dwordx4 v[60:63], v40, s[32:35], s5 offen offset:1024 sc1
    buffer_load_dwordx4 v[64:67], v40, s[32:35], s5 offen offset:1536 sc1
    s_waitcnt vmcnt(3)
    v_xor_b32 v54, s56, v54
    s_waitcnt vmcnt(2)
    v_xor_b32 v58, s56, v58
    s_waitcnt vmcnt(1)
    v_xor_b32 v62, s56, v62
    s_waitcnt vmcnt(0)
    v_xor_b32 v66, s56, v66
    v_or3_b32 v54, v54, v58, v62
    v_or_b32 v54, v54, v66
    v_cmp_ne_u32 vcc, 0, v54
    s_mov_b32 s97, 0
    s_nop 0
    s_cbranch_vccnz Lxr85
Lxb86:
    v_add_f32 v52, v52, v56
    v_add_f32 v60, v60, v64
    v_add_f32 v53, v53, v57
    v_add_f32 v61, v61, v65
    v_add_f32 v27, v52, v60
    v_add_f32 v24, v53, v61
    v_mul_f32 v27, s96, v27
    v_mul_f32 v24, s96, v24
    v_fma_f32 v24, -v27, v27, v24
    v_max_f32 v24, 0, v24
    v_add_f32 v50, 925353388, v24
    v_rsq_f32 v25, v50
    v_cvt_pk_bf16_f32 v24, -v27, -v27
    v_mul_f32 v26, 0xc0135761, v25
    v_mul_f32 v28, 0x3d372713, v25
    v_and_b32 v51, 0xffff0000, v24
    v_add_f32 v51, v51, v27
    v_mul_f32 v27, v50, v25
    v_mul_f32 v25, v25, v26
    v_and_b32 v26, 0xffffff7f, v26
    v_mul_f32 v25, v25, v28
    v_and_b32 v27, 0xffffff7f, v27
    v_and_b32 v25, 0xffffff7f, v25
    ds_write_b128 v42, v[24:27] offset:0
    v_cvt_pk_bf16_f32 v24, -v51, -v51
    ds_write_b128 v42, v[24:27] offset:512
    s_waitcnt lgkmcnt(0)
    s_mov_b64 exec, 0x80
    ds_write_b32 v38, v38 offset:8192
    s_mov_b64 exec, -1
    s_mov_b32 s97, 0
    s_branch Ltx88
Ltw87:
    s_sleep 1
    s_add_u32 s97, s97, 1
    s_cmp_gt_u32 s97, 2097152
    s_cbranch_scc1 Lty89
Ltx88:
    ds_read_b32 v4, v38 offset:10240
    s_waitcnt lgkmcnt(0)
    v_cmp_eq_u32 vcc, 0, v4
    s_nop 1
    s_cbranch_vccnz Ltw87
Lty89:
    s_lshl_b32 s72, s59, 8
    s_add_u32 s72, s72, 33570844
    s_lshl_b32 s73, s60, 5
    s_add_u32 s73, s73, s72
    v_lshlrev_b32 v37, 5, v2
    v_mov_b32 v4, s56
    s_waitcnt vmcnt(0)
    s_mov_b64 exec, 1
    s_cmp_eq_u32 s61, 0
    s_cbranch_scc1 Lxs90
    buffer_store_dword v4, off, s[32:35], s73
Lxb91:
    s_mov_b64 exec, -1
    s_mov_b32 exec_lo, 0xff
    s_mov_b32 exec_hi, 0
    buffer_load_dword v4, v37, s[32:35], s72 offen sc1
    s_waitcnt vmcnt(0)
    v_subrev_u32 v4, s56, v4
    v_cmp_lt_u32 vcc, 15, v4
    s_mov_b32 s97, 0
    s_nop 0
    s_cbranch_vccnz Lpr92
Lpb93:
    s_mov_b64 exec, -1
    s_mov_b64 exec, 0x80
    ds_write_b32 v38, v38 offset:2048
    s_mov_b64 exec, -1
    s_mul_i32 s70, s57, 28
    s_mul_i32 s71, s58, 7
    s_add_u32 s70, s70, s71
    s_lshl_b32 s71, s70, 10
    s_add_u32 s71, s71, 10485760
    s_add_u32 s69, s71, 2097152
    s_lshl_b32 s70, s70, 11
    s_add_u32 s70, s70, 16777216
    s_mov_b32 m0, 151168
    s_mov_b32 exec_hi, 0x00ffffff
    s_mov_b32 s97, 0
    s_branch Ltx95
Ltw94:
    s_sleep 1
    s_add_u32 s97, s97, 1
    s_cmp_gt_u32 s97, 2097152
    s_cbranch_scc1 Lty96
Ltx95:
    ds_read_b32 v4, v38 offset:2048
    s_waitcnt lgkmcnt(0)
    v_cmp_eq_u32 vcc, 0, v4
    s_nop 1
    s_cbranch_vccnz Ltw94
Lty96:
    buffer_load_dword v7, s[32:35], s70 offen sc1 lds
    s_add_u32 s70, s70, 7168
    buffer_load_dword v7, s[32:35], s70 offen sc1 lds
    s_add_u32 s70, s70, 7168
    s_mov_b32 exec_hi, -1
    s_cmp_lg_u32 s2, 0
    s_cbranch_scc1 Lc97
    v_mov_b32 v4, s56
    s_mov_b32 s70, 33685504
    s_mov_b64 exec, 1
    buffer_store_dword v4, off, s[32:35], s70 sc1
    s_mov_b64 exec, -1
Lc97:
    s_waitcnt vmcnt(0)
Lend:
    s_endpgm
Lnonconv:
    v_lshlrev_b32 v15, 7, v2
    s_lshl_b32 s71, s52, 10
    s_lshl4_add_u32 s66, s2, 33751040
    s_add_u32 s77, s71, 111104
    v_add_u32 v13, s71, v1
    s_lshl_b32 s70, s52, 13
    v_add_u32 v14, s70, v1
    s_lshl_b32 s70, s52, 9
    s_mul_i32 s72, s53, 4352
    s_add_u32 s70, s70, s72
    s_add_u32 s70, s70, 33751040
    v_and_b32 v17, 0x1f0, v1
    v_add_u32 v17, s70, v17
    s_mul_i32 s75, s52, 4608
    s_add_u32 s75, s75, 31744
    v_add_u32_sdwa v20, s75, v80 dst_sel:DWORD dst_unused:UNUSED_PAD src0_sel:DWORD src1_sel:WORD_0
    v_mov_b32_sdwa v10, v77 dst_sel:DWORD dst_unused:UNUSED_PAD src0_sel:WORD_1
    v_mov_b32_sdwa v11, v78 dst_sel:DWORD dst_unused:UNUSED_PAD src0_sel:WORD_0
    v_add_u32_sdwa v15, s77, v79 dst_sel:DWORD dst_unused:UNUSED_PAD src0_sel:DWORD src1_sel:WORD_0
    s_and_b32 s70, s52, 3
    s_lshr_b32 s71, s52, 2
    s_mul_i32 s73, s71, 8320
    s_add_u32 s73, s73, 93312
    v_add_u32 v18, s73, v18
    s_lshl_b32 s72, s70, 7
    s_sub_u32 s72, s73, s72
    s_add_u32 s72, s72, 3456
    v_add_u32_sdwa v4, s72, v76 dst_sel:DWORD dst_unused:UNUSED_PAD src0_sel:DWORD src1_sel:WORD_0
    s_lshl_b32 s72, s70, 8
    s_sub_u32 s72, 110080, s72
    v_xor_b32 v16, 16, v15
    v_add_u32_sdwa v8, s72, v76 dst_sel:DWORD dst_unused:UNUSED_PAD src0_sel:DWORD src1_sel:WORD_1
    v_add_u32_sdwa v9, s72, v77 dst_sel:DWORD dst_unused:UNUSED_PAD src0_sel:DWORD src1_sel:WORD_0
    s_xor_b32 s72, s70, s71
    s_and_b32 s72, s72, 1
    s_lshl_b32 s72, s72, 4
    v_subrev_u32 v5, 1024, v4
    v_subrev_u32 v6, 2048, v4
    v_subrev_u32 v7, 3072, v4
    v_xor_b32 v8, s72, v8
    v_xor_b32 v9, s72, v9
    s_lshl_b32 s72, s70, 2
    s_mul_i32 s70, s71, 12320
    s_add_u32 s70, s70, 68608
    s_mov_b32 s73, 97408
    v_xor_b32_sdwa v19, s72, v79 dst_sel:DWORD dst_unused:UNUSED_PAD src0_sel:DWORD src1_sel:WORD_1
    v_add_u32_sdwa v88, s73, v83 dst_sel:DWORD dst_unused:UNUSED_PAD src0_sel:DWORD src1_sel:WORD_0
    v_mov_b32 v84, 0
    v_mov_b32 v85, 0
    v_mov_b32 v86, 0
    v_mov_b32 v87, 0
    v_add_u32 v19, s70, v19
    s_add_u32 s72, s70, 12288
    s_bitcmp1_b32 s52, 0
    s_cselect_b64 vcc, -1, 0
    v_add_u32 v89, 110080, v1
    v_writelane_b32 v88, s72, 63
    v_cndmask_b32 v88, v89, v88, vcc
    ds_write_b128 v88, v[84:87]
    v_add_u32_sdwa v132, s70, v66 dst_sel:DWORD dst_unused:UNUSED_PAD src0_sel:DWORD src1_sel:WORD_0
    v_add_u32_sdwa v133, s70, v66 dst_sel:DWORD dst_unused:UNUSED_PAD src0_sel:DWORD src1_sel:WORD_1
    v_add_u32_sdwa v134, s70, v67 dst_sel:DWORD dst_unused:UNUSED_PAD src0_sel:DWORD src1_sel:WORD_0
    v_add_u32_sdwa v135, s70, v67 dst_sel:DWORD dst_unused:UNUSED_PAD src0_sel:DWORD src1_sel:WORD_1
    v_add_u32_sdwa v136, s70, v68 dst_sel:DWORD dst_unused:UNUSED_PAD src0_sel:DWORD src1_sel:WORD_0
    v_add_u32_sdwa v137, s70, v68 dst_sel:DWORD dst_unused:UNUSED_PAD src0_sel:DWORD src1_sel:WORD_1
    v_add_u32_sdwa v138, s70, v69 dst_sel:DWORD dst_unused:UNUSED_PAD src0_sel:DWORD src1_sel:WORD_0
    v_add_u32_sdwa v139, s70, v69 dst_sel:DWORD dst_unused:UNUSED_PAD src0_sel:DWORD src1_sel:WORD_1
    v_add_u32_sdwa v140, s70, v70 dst_sel:DWORD dst_unused:UNUSED_PAD src0_sel:DWORD src1_sel:WORD_0
    v_lshlrev_b32 v15, 7, v2
    v_lshrrev_b32 v19, 3, v0
    v_and_b32 v20, 7, v0
    v_lshlrev_b32 v21, 9, v19
    v_lshl_add_u32 v21, v20, 4, v21
    s_andn2_b32 s70, 1, s58
    v_add_u32 v20, s70, v20
    v_mul_u32_u24 v22, 768, v19
    v_lshrrev_b32 v18, 2, v20
    v_lshl_add_u32 v22, v18, 8, v22
    v_and_b32 v18, 3, v20
    v_lshl_add_u32 v22, v18, 4, v22
    v_add_u32 v22, 106880, v22
    s_mul_i32 s88, s57, 28672
    s_add_u32 s88, s88, 12582912
    v_add_u32 v26, 65536, v17
    s_waitcnt vmcnt(0)
    s_barrier
    s_cmp_lg_u32 s52, 0
    s_cbranch_scc1 Lc98
    v_mov_b32 v118, s83
    v_mul_u32_u24 v119, 4352, v2
    s_mov_b64 exec, 0xff
    buffer_store_dword v118, v119, s[32:35], s66 offen sc1
    s_mov_b64 exec, -1
Lc98:
    s_lshl4_add_u32 s66, s2, 33816576
    s_mov_b32 m0, s93
    s_nop 0
    buffer_load_dwordx4 v23, s[44:47], s90 offen lds
    s_add_u32 m0, s93, 1024
    s_nop 0
    buffer_load_dwordx4 v23, s[44:47], s89 offen lds
    s_mov_b32 m0, s75
    s_waitcnt vmcnt(0)
    ds_read_b64_tr_b16 v[240:241], v24 offset:0
    ds_read_b64_tr_b16 v[242:243], v24 offset:256
    ds_read_b64_tr_b16 v[244:245], v24 offset:1024
    ds_read_b64_tr_b16 v[246:247], v24 offset:1280
    s_cmp_lg_u32 s43, 2
    s_cbranch_scc1 Lc99
    s_mov_b32 vcc_lo, 0xf0f00f0f
    s_mov_b32 vcc_hi, 0xf0f00f0f
    v_mov_b32 v252, 0x3f803f80
    v_cndmask_b32 v248, 0, v252, vcc
    v_cndmask_b32 v249, 0, v252, vcc
    v_cndmask_b32 v250, 0, v252, vcc
    v_cndmask_b32 v251, 0, v252, vcc
    s_lshr_b32 s72, s62, 4
    s_add_u32 s72, s72, 7289856
    s_waitcnt lgkmcnt(2)
    v_mfma_f32_16x16x32_bf16 v[252:255], v[248:251], v[240:243], 0
    s_waitcnt lgkmcnt(0)
    v_mfma_f32_16x16x32_bf16 v[252:255], v[248:251], v[244:247], v[252:255]
    v_lshlrev_b32 v248, 2, v2
    s_mov_b32 exec_hi, 0
    s_nop 5
    buffer_store_dword v252, v248, s[32:35], s72 offen sc1
    s_mov_b32 exec_hi, -1
Lc99:
    s_mov_b32 s44, s30
    s_mov_b32 s45, s31
    s_mov_b32 s46, s67
    s_waitcnt lgkmcnt(2)
    buffer_store_dwordx4 v[240:243], v1, s[44:47], s62 offen sc1
    s_waitcnt lgkmcnt(0)
    buffer_store_dwordx4 v[244:247], v1, s[44:47], s63 offen sc1
    buffer_load_dword v18, v17, s[32:35], 0 offen sc1
    s_waitcnt vmcnt(0)
    v_subrev_u32 v18, s56, v18
    v_cmp_lt_u32 vcc, 15, v18
    s_mov_b32 s97, 0
    s_nop 0
    s_cbranch_vccnz Lpr100
Lpb101:
    s_barrier
    s_cmp_lg_u32 s52, 1
    s_cbranch_scc1 Lc102
    v_mov_b32 v118, s56
    v_mul_u32_u24 v119, 4352, v2
    s_mov_b64 exec, 0xff
    buffer_store_dword v118, v119, s[32:35], s66 offen sc1
    s_mov_b64 exec, -1
Lc102:
    s_add_u32 s70, s85, 6144
    buffer_load_dwordx4 v[144:147], v1, s[48:51], s84 offen offset:0
    buffer_load_dwordx4 v[148:151], v1, s[48:51], s84 offen offset:1024
    buffer_load_dwordx4 v[152:155], v1, s[48:51], s84 offen offset:2048
    buffer_load_dwordx4 v[156:159], v1, s[48:51], s84 offen offset:3072
    s_add_u32 s84, s84, 4096
    buffer_load_dwordx4 v[160:163], v1, s[48:51], s84 offen offset:0
    buffer_load_dwordx4 v[164:167], v1, s[48:51], s84 offen offset:1024
    buffer_load_dwordx4 v[168:171], v1, s[48:51], s84 offen offset:2048
    buffer_load_dwordx4 v[172:175], v1, s[48:51], s84 offen offset:3072
    s_add_u32 s84, s84, 4096
    buffer_load_dwordx4 v[176:179], v1, s[48:51], s84 offen offset:0
    buffer_load_dwordx4 v[180:183], v1, s[48:51], s84 offen offset:1024
    buffer_load_dwordx4 v[184:187], v1, s[48:51], s84 offen offset:2048
    buffer_load_dwordx4 v[188:191], v1, s[48:51], s84 offen offset:3072
    s_add_u32 s84, s84, 4096
    buffer_load_dwordx4 v[192:195], v1, s[48:51], s84 offen offset:0
    buffer_load_dwordx4 v[196:199], v1, s[48:51], s84 offen offset:1024
    buffer_load_dwordx4 v[200:203], v1, s[48:51], s85 offen offset:0
    buffer_load_dword v119, v15, s[48:51], s70 offen
    s_waitcnt vmcnt(0)
    s_branch Ljoin
Lur5:
    buffer_load_dwordx4 v[120:123], v10, s[32:35], s74 offen sc1
    s_add_u32 s97, s97, 1
    s_cmp_gt_u32 s97, 262144
    s_waitcnt vmcnt(0)
    s_cbranch_scc1 Lub6
    v_xor_b32 v120, s78, v120
    v_xor_b32 v121, s79, v121
    v_xor_b32 v122, s80, v122
    v_xor_b32 v123, s81, v123
    v_or3_b32 v119, v120, v121, v122
    v_or_b32 v119, v119, v123
    v_and_b32 v119, 0x70007000, v119
    v_cmp_ne_u32 vcc, 0, v119
    s_nop 1
    s_cbranch_vccnz Lur5
    s_branch Lub6
Lpr7:
    s_sleep 1
    buffer_load_dword v27, v17, s[32:35], 0 offen sc1
    s_add_u32 s97, s97, 1
    s_cmp_gt_u32 s97, 262144
    s_waitcnt vmcnt(0)
    s_cbranch_scc1 Lpb8
    v_subrev_u32 v27, s56, v27
    v_cmp_lt_u32 vcc, 15, v27
    s_nop 1
    s_cbranch_vccnz Lpr7
    s_branch Lpb8
Lpr13:
    s_sleep 4
    buffer_load_dword v8, v9, s[32:35], s68 offen sc1
    s_add_u32 s97, s97, 1
    s_cmp_gt_u32 s97, 262144
    s_waitcnt vmcnt(0)
    s_cbranch_scc1 Lpb14
    v_subrev_u32 v8, s56, v8
    v_cmp_lt_u32 vcc, 15, v8
    s_nop 1
    s_cbranch_vccnz Lpr13
    s_branch Lpb14
Lhr15:
    buffer_load_dwordx4 v[8:11], v4, s[32:35], s88 offen offset:0 sc1
    buffer_load_dwordx4 v[12:15], v4, s[32:35], s88 offen offset:128 sc1
    buffer_load_dwordx4 v[16:19], v4, s[32:35], s88 offen offset:256 sc1
    buffer_load_dwordx4 v[20:23], v4, s[32:35], s88 offen offset:384 sc1
    buffer_load_dword v25, v26, s[32:35], 0 offen sc1
    s_add_u32 s97, s97, 1
    s_cmp_gt_u32 s97, 262144
    s_waitcnt vmcnt(0)
    s_cbranch_scc1 Lhb16
    v_or3_b32 v24, v8, v12, v16
    v_or_b32 v24, v24, v20
    v_and_b32 v24, 1, v24
    v_cmp_eq_u32 vcc, 1, v24
    s_nop 1
    s_cbranch_vccnz Lhr15
    s_branch Lhb16
Lpr17:
    s_sleep 2
    buffer_load_dword v25, v26, s[32:35], 0 offen sc1
    s_add_u32 s97, s97, 1
    s_cmp_gt_u32 s97, 262144
    s_waitcnt vmcnt(0)
    s_cbranch_scc1 Lpb18
    v_subrev_u32 v25, s56, v25
    v_cmp_lt_u32 vcc, 15, v25
    s_nop 1
    s_cbranch_vccnz Lpr17
    s_branch Lpb18
Les19:
    ds_read_b32 v49, v4
    ds_read_b128 v[36:39], v50
    ds_read_b128 v[40:43], v50 offset:256
    s_add_u32 s97, s97, 1
    s_cmp_gt_u32 s97, 2097152
    s_waitcnt lgkmcnt(0)
    s_cbranch_scc1 Leb20
    v_cmp_eq_u32 vcc, 0, v49
    s_nop 1
    s_cbranch_vccnz Les19
    s_branch Leb20
Lxs21:
    s_nop 7
    s_nop 3
    buffer_store_dwordx4 v[20:23], v1, s[32:35], s70 offen sc1
    s_branch Lxb22
Lfr23:
    s_add_u32 m0, s4, 0
    s_add_u32 s68, s4, s8
    buffer_load_dwordx4 v1, s[32:35], s68 offen sc1 lds
    s_add_u32 m0, s5, 0
    s_add_u32 s68, s5, s8
    buffer_load_dwordx4 v1, s[32:35], s68 offen sc1 lds
    s_add_u32 m0, s6, 0
    s_add_u32 s68, s6, s8
    buffer_load_dwordx4 v1, s[32:35], s68 offen sc1 lds
    s_add_u32 s97, s97, 1
    s_cmp_gt_u32 s97, 262144
    s_waitcnt vmcnt(0)
    s_cbranch_scc1 Lfb24
    ds_read_b32 v8, v47 offset:0
    ds_read_b32 v9, v47 offset:7168
    ds_read_b32 v10, v47 offset:14336
    ds_read_b32 v11, v47 offset:21504
    s_waitcnt lgkmcnt(0)
    v_and_b32 v8, v8, v9
    v_and_b32 v10, v10, v11
    v_and_b32 v8, 1, v8
    v_and_b32 v8, v8, v10
    v_cmp_eq_u32 vcc, 0, v8
    s_nop 1
    s_cbranch_vccnz Lfr23
    s_branch Lfb24
Lxs25:
    s_nop 7
    s_nop 3
    buffer_store_dwordx4 v[20:23], v1, s[32:35], s71 offen sc1
    s_branch Lxb26
Lfr27:
    s_add_u32 m0, s7, 28672
    s_add_u32 s68, s9, 0
    buffer_load_dwordx4 v1, s[32:35], s68 offen sc1 lds
    s_add_u32 m0, s7, 35840
    s_add_u32 s68, s9, 7168
    buffer_load_dwordx4 v1, s[32:35], s68 offen sc1 lds
    s_add_u32 m0, s7, 43008
    s_add_u32 s68, s9, 14336
    buffer_load_dwordx4 v1, s[32:35], s68 offen sc1 lds
    s_add_u32 m0, s7, 50176
    s_add_u32 s68, s9, 21504
    buffer_load_dwordx4 v1, s[32:35], s68 offen sc1 lds
    s_add_u32 s97, s97, 1
    s_cmp_gt_u32 s97, 262144
    s_waitcnt vmcnt(0)
    s_cbranch_scc1 Lfb28
    ds_read_b32 v8, v47 offset:0
    ds_read_b32 v9, v47 offset:7168
    ds_read_b32 v10, v47 offset:14336
    ds_read_b32 v11, v47 offset:21504
    s_waitcnt lgkmcnt(0)
    v_and_b32 v8, v8, v9
    v_and_b32 v10, v10, v11
    v_and_b32 v8, 1, v8
    v_and_b32 v8, v8, v10
    v_cmp_eq_u32 vcc, 0, v8
    s_nop 1
    s_cbranch_vccnz Lfr27
    s_branch Lfb28
Lfr29:
    s_add_u32 m0, s4, 57344
    s_add_u32 s68, s4, s8
    buffer_load_dwordx4 v1, s[32:35], s68 offen sc1 lds
    s_add_u32 m0, s5, 57344
    s_add_u32 s68, s5, s8
    buffer_load_dwordx4 v1, s[32:35], s68 offen sc1 lds
    s_add_u32 m0, s6, 57344
    s_add_u32 s68, s6, s8
    buffer_load_dwordx4 v1, s[32:35], s68 offen sc1 lds
    s_mov_b32 m0, s21
    s_add_u32 s97, s97, 1
    s_cmp_gt_u32 s97, 262144
    s_waitcnt vmcnt(0)
    s_cbranch_scc1 Lfb30
    ds_read_b32 v24, v47 offset:28672
    ds_read_b32 v25, v47 offset:35840
    ds_read_b32 v26, v47 offset:43008
    ds_read_b32 v27, v47 offset:50176
    s_waitcnt lgkmcnt(0)
    v_and_b32 v24, v24, v25
    v_and_b32 v26, v26, v27
    v_and_b32 v24, 1, v24
    v_and_b32 v24, v24, v26
    v_cmp_eq_u32 vcc, 0, v24
    s_nop 1
    s_cbranch_vccnz Lfr29
    s_branch Lfb30
Lls31:
    s_mov_b32 s97, 0
Lls31a:
    ds_read_b32 v4, v46 offset:10240
    s_add_u32 s97, s97, 1
    s_cmp_gt_u32 s97, 2097152
    s_waitcnt lgkmcnt(0)
    s_cbranch_scc1 Llb32
    v_cmp_eq_u32 vcc, 0, v4
    s_nop 1
    s_cbranch_vccz Llb32
    s_sleep 1
    s_branch Lls31a
Lls33:
    s_mov_b32 s97, 0
Lls33a:
    ds_read_b32 v4, v46 offset:8192
    s_add_u32 s97, s97, 1
    s_cmp_gt_u32 s97, 2097152
    s_waitcnt lgkmcnt(0)
    s_cbranch_scc1 Llb34
    v_cmp_eq_u32 vcc, 0, v4
    s_nop 1
    s_cbranch_vccz Llb34
    s_sleep 1
    s_branch Lls33a
Lls35:
    s_mov_b32 s97, 0
Lls35a:
    ds_read_b32 v4, v46 offset:0
    s_add_u32 s97, s97, 1
    s_cmp_gt_u32 s97, 2097152
    s_waitcnt lgkmcnt(0)
    s_cbranch_scc1 Llb36
    v_cmp_eq_u32 vcc, 0, v4
    s_nop 1
    s_cbranch_vccz Llb36
    s_sleep 1
    s_branch Lls35a
Lls37:
    s_mov_b32 s97, 0
Lls37a:
    ds_read_b32 v4, v46 offset:2048
    s_add_u32 s97, s97, 1
    s_cmp_gt_u32 s97, 2097152
    s_waitcnt lgkmcnt(0)
    s_cbranch_scc1 Llb38
    v_cmp_eq_u32 vcc, 0, v4
    s_nop 1
    s_cbranch_vccz Llb38
    s_sleep 1
    s_branch Lls37a
Lxs39:
    s_nop 7
    s_nop 3
    buffer_store_dwordx4 v[108:111], v1, s[32:35], s14 offen offset:0 sc1
    s_branch Lxb40
Lls41:
    s_mov_b32 s97, 0
Lls41a:
    ds_read_b32 v4, v46 offset:4096
    s_add_u32 s97, s97, 1
    s_cmp_gt_u32 s97, 2097152
    s_waitcnt lgkmcnt(0)
    s_cbranch_scc1 Llb42
    v_cmp_eq_u32 vcc, 0, v4
    s_nop 1
    s_cbranch_vccz Llb42
    s_sleep 1
    s_branch Lls41a
Lxs43:
    s_nop 7
    s_nop 3
    buffer_store_dwordx4 v[196:199], v1, s[32:35], s14 offen offset:1024 sc1
    s_branch Lxb44
Lxs45:
    s_nop 7
    s_nop 3
    buffer_store_dwordx4 v[108:111], v1, s[32:35], s12 offen offset:0 sc1
    s_branch Lxb46
Lxs47:
    s_nop 7
    s_nop 3
    buffer_store_dwordx4 v[196:199], v1, s[32:35], s13 offen offset:0 sc1
    s_branch Lxb48
Lxs49:
    s_nop 7
    s_nop 3
    buffer_store_dword v45, off, s[32:35], s69 sc1
    s_branch Lxb50
Lls51:
    s_mov_b32 s97, 0
Lls51a:
    ds_read_b32 v4, v46 offset:6144
    s_add_u32 s97, s97, 1
    s_cmp_gt_u32 s97, 2097152
    s_waitcnt lgkmcnt(0)
    s_cbranch_scc1 Llb52
    v_cmp_eq_u32 vcc, 0, v4
    s_nop 1
    s_cbranch_vccz Llb52
    s_sleep 1
    s_branch Lls51a
Lxs53:
    s_nop 7
    s_nop 3
    buffer_store_dword v45, off, s[32:35], s69 sc1
    s_branch Lxb54
Lpr55:
    buffer_load_dword v47, off, s[32:35], s70 sc1
    s_add_u32 s97, s97, 1
    s_cmp_gt_u32 s97, 262144
    s_waitcnt vmcnt(0)
    s_cbranch_scc1 Lpb56
    v_subrev_u32 v47, s56, v47
    v_cmp_lt_u32 vcc, 15, v47
    s_nop 1
    s_cbranch_vccnz Lpr55
    s_branch Lpb56
Lsr57:
    buffer_load_dwordx4 v[172:175], v1, s[32:35], s15 offen offset:0 sc1
    buffer_load_dwordx4 v[176:179], v1, s[32:35], s16 offen offset:0 sc1
    s_add_u32 s97, s97, 1
    s_cmp_gt_u32 s97, 262144
    s_waitcnt vmcnt(0)
    s_cbranch_scc1 Lsb58
    v_or_b32 v4, v172, v176
    v_and_b32 v4, 1, v4
    v_cmp_eq_u32 vcc, 1, v4
    s_nop 1
    s_cbranch_vccnz Lsr57
    s_branch Lsb58
Lxs59:
    s_nop 7
    s_nop 3
    buffer_store_dwordx4 v[108:111], v1, s[32:35], s15 offen offset:0 sc1
    s_branch Lxb60
Lxs61:
    s_nop 7
    s_nop 3
    buffer_store_dwordx4 v[196:199], v1, s[32:35], s16 offen offset:0 sc1
    s_branch Lxb62
Lpr63:
    buffer_load_dword v45, v7, s[32:35], s72 offen sc1
    s_add_u32 s97, s97, 1
    s_cmp_gt_u32 s97, 262144
    s_waitcnt vmcnt(0)
    s_cbranch_scc1 Lpb64
    v_subrev_u32 v45, s56, v45
    v_cmp_lt_u32 vcc, 15, v45
    s_nop 1
    s_cbranch_vccnz Lpr63
    s_branch Lpb64
Lxs65:
    s_nop 7
    s_nop 3
    buffer_store_dwordx4 v[24:27], v1, s[32:35], s17 offen offset:0 sc1
    s_branch Lxb66
Lxs67:
    s_nop 7
    s_nop 3
    buffer_store_dwordx4 v[28:31], v1, s[32:35], s17 offen offset:1024 sc1
    s_branch Lxb68
Ler69:
    buffer_load_dwordx4 v[52:55], v5, s[32:35], s74 offen offset:0 sc1
    buffer_load_dwordx4 v[56:59], v5, s[32:35], s74 offen offset:256 sc1
    buffer_load_dwordx4 v[60:63], v5, s[32:35], s75 offen offset:0 sc1
    buffer_load_dwordx4 v[64:67], v5, s[32:35], s75 offen offset:256 sc1
    s_add_u32 s97, s97, 1
    s_cmp_gt_u32 s97, 262144
    s_waitcnt vmcnt(0)
    s_cbranch_scc1 Leb70
    v_and_b32 v8, v52, v56
    v_and_b32 v9, v60, v64
    v_and_b32 v8, 1, v8
    v_and_b32 v8, v8, v9
    v_cmp_eq_u32 vcc, 0, v8
    s_nop 1
    s_cbranch_vccnz Ler69
    s_branch Leb70
Lpr72:
    s_sleep 4
    buffer_load_dword v8, v9, s[32:35], s68 offen sc1
    s_add_u32 s97, s97, 1
    s_cmp_gt_u32 s97, 262144
    s_waitcnt vmcnt(0)
    s_cbranch_scc1 Lpb73
    v_subrev_u32 v8, s56, v8
    v_cmp_lt_u32 vcc, 15, v8
    s_nop 1
    s_cbranch_vccnz Lpr72
    s_branch Lpb73
Lhr74:
    buffer_load_dwordx4 v[8:11], v4, s[32:35], s88 offen offset:0 sc1
    buffer_load_dwordx4 v[12:15], v4, s[32:35], s88 offen offset:128 sc1
    buffer_load_dwordx4 v[16:19], v4, s[32:35], s88 offen offset:256 sc1
    buffer_load_dwordx4 v[20:23], v4, s[32:35], s88 offen offset:384 sc1
    buffer_load_dword v25, v26, s[32:35], 0 offen sc1
    s_add_u32 s97, s97, 1
    s_cmp_gt_u32 s97, 262144
    s_waitcnt vmcnt(0)
    s_cbranch_scc1 Lhb75
    v_or3_b32 v24, v8, v12, v16
    v_or_b32 v24, v24, v20
    v_and_b32 v24, 1, v24
    v_cmp_eq_u32 vcc, 1, v24
    s_nop 1
    s_cbranch_vccnz Lhr74
    s_branch Lhb75
Lpr76:
    s_sleep 2
    buffer_load_dword v25, v26, s[32:35], 0 offen sc1
    s_add_u32 s97, s97, 1
    s_cmp_gt_u32 s97, 262144
    s_waitcnt vmcnt(0)
    s_cbranch_scc1 Lpb77
    v_subrev_u32 v25, s56, v25
    v_cmp_lt_u32 vcc, 15, v25
    s_nop 1
    s_cbranch_vccnz Lpr76
    s_branch Lpb77
Lpr78:
    s_sleep 4
    buffer_load_dword v4, v37, s[32:35], s72 offen sc1
    s_add_u32 s97, s97, 1
    s_cmp_gt_u32 s97, 262144
    s_waitcnt vmcnt(0)
    s_cbranch_scc1 Lpb79
    v_subrev_u32 v4, s56, v4
    v_cmp_lt_u32 vcc, 15, v4
    s_nop 1
    s_cbranch_vccnz Lpr78
    s_branch Lpb79
Lxs83:
    s_nop 7
    s_nop 3
    buffer_store_dwordx4 v[8:11], v1, s[32:35], s4 offen sc1
    s_branch Lxb84
Lxr85:
    buffer_load_dwordx4 v[52:55], v40, s[32:35], s5 offen offset:0 sc1
    buffer_load_dwordx4 v[56:59], v40, s[32:35], s5 offen offset:512 sc1
    buffer_load_dwordx4 v[60:63], v40, s[32:35], s5 offen offset:1024 sc1
    buffer_load_dwordx4 v[64:67], v40, s[32:35], s5 offen offset:1536 sc1
    s_add_u32 s97, s97, 1
    s_cmp_gt_u32 s97, 262144
    s_waitcnt vmcnt(0)
    s_cbranch_scc1 Lxb86
    v_xor_b32 v54, s56, v54
    v_xor_b32 v58, s56, v58
    v_xor_b32 v62, s56, v62
    v_xor_b32 v66, s56, v66
    v_or3_b32 v54, v54, v58, v62
    v_or_b32 v54, v54, v66
    v_cmp_ne_u32 vcc, 0, v54
    s_nop 1
    s_cbranch_vccnz Lxr85
    s_branch Lxb86
Lxs90:
    s_nop 7
    s_nop 3
    buffer_store_dword v4, off, s[32:35], s73 sc1
    s_branch Lxb91
Lpr92:
    s_sleep 2
    buffer_load_dword v4, v37, s[32:35], s72 offen sc1
    s_add_u32 s97, s97, 1
    s_cmp_gt_u32 s97, 262144
    s_waitcnt vmcnt(0)
    s_cbranch_scc1 Lpb93
    v_subrev_u32 v4, s56, v4
    v_cmp_lt_u32 vcc, 15, v4
    s_nop 1
    s_cbranch_vccnz Lpr92
    s_branch Lpb93
Lpr100:
    s_sleep 8
    buffer_load_dword v18, v17, s[32:35], 0 offen sc1
    s_add_u32 s97, s97, 1
    s_cmp_gt_u32 s97, 262144
    s_waitcnt vmcnt(0)
    s_cbranch_scc1 Lpb101
    v_subrev_u32 v18, s56, v18
    v_cmp_lt_u32 vcc, 15, v18
    s_nop 1
    s_cbranch_vccnz Lpr100
    s_branch Lpb101
.p2align 7
.type tail_table,@object
tail_table:
.long 0, 0
.long 896, 28
.long 1792, 56
.long 2688, 84
.long 3584, 0
.long 4480, 28
.long 5376, 56
.long 6272, 84
.long 7168, 0
.long 8064, 28
.long 8960, 56
.long 9856, 84
.long 10752, 0
.long 11648, 28
.long 12544, 56
.long 13440, 84
.long 14336, 0
.long 15232, 28
.long 16128, 56
.long 17024, 84
.long 17920, 0
.long 18816, 28
.long 19712, 56
.long 20608, 84
.long 21504, 0
.long 22400, 28
.long 23296, 56
.long 24192, 84
.long 25088, 0
.long 25984, 28
.long 26880, 56
.long 27776, 84
.long 16, 0
.long 912, 28
.long 1808, 56
.long 2704, 84
.long 3600, 0
.long 4496, 28
.long 5392, 56
.long 6288, 84
.long 7184, 0
.long 8080, 28
.long 8976, 56
.long 9872, 84
.long 10768, 0
.long 11664, 28
.long 12560, 56
.long 13456, 84
.long 14352, 0
.long 15248, 28
.long 16144, 56
.long 17040, 84
.long 17936, 0
.long 18832, 28
.long 19728, 56
.long 20624, 84
.long 21520, 0
.long 22416, 28
.long 23312, 56
.long 24208, 84
.long 25104, 0
.long 26000, 28
.long 26896, 56
.long 27792, 84
.short 0x3f80, 0, 0, 0, 0, 0, 0, 0
.short 0, 0x3f80, 0, 0, 0, 0, 0, 0
.short 0, 0, 0x3f80, 0, 0, 0, 0, 0
.short 0, 0, 0, 0x3f80, 0, 0, 0, 0
.short 0, 0, 0, 0, 0x3f80, 0, 0, 0
.short 0, 0, 0, 0, 0, 0x3f80, 0, 0
.short 0, 0, 0, 0, 0, 0, 0x3f80, 0
.short 0, 0, 0, 0, 0, 0, 0, 0x3f80
.short 0, 0, 0, 0, 0, 0, 0, 0
.short 0, 0, 0, 0, 0, 0, 0, 0
.short 0, 0, 0, 0, 0, 0, 0, 0
.short 0, 0, 0, 0, 0, 0, 0, 0
.short 0, 0, 0, 0, 0, 0, 0, 0
.short 0, 0, 0, 0, 0, 0, 0, 0
.short 0, 0, 0, 0, 0, 0, 0, 0
.short 0, 0, 0, 0, 0, 0, 0, 0
.short 0, 0, 0, 0, 0, 0, 0, 0
.short 0, 0, 0, 0, 0, 0, 0, 0
.short 0, 0, 0, 0, 0, 0, 0, 0
.short 0, 0, 0, 0, 0, 0, 0, 0
.short 0, 0, 0, 0, 0, 0, 0, 0
.short 0, 0, 0, 0, 0, 0, 0, 0
.short 0, 0, 0, 0, 0, 0, 0, 0
.short 0, 0, 0, 0, 0, 0, 0, 0
.short 0x3f80, 0, 0, 0, 0, 0, 0, 0
.short 0, 0x3f80, 0, 0, 0, 0, 0, 0
.short 0, 0, 0x3f80, 0, 0, 0, 0, 0
.short 0, 0, 0, 0x3f80, 0, 0, 0, 0
.short 0, 0, 0, 0, 0x3f80, 0, 0, 0
.short 0, 0, 0, 0, 0, 0x3f80, 0, 0
.short 0, 0, 0, 0, 0, 0, 0x3f80, 0
.short 0, 0, 0, 0, 0, 0, 0, 0x3f80
.short 0x3f80, 0, 0, 0, 0, 0, 0, 0
.short 0, 0x3f80, 0, 0, 0, 0, 0, 0
.short 0, 0, 0x3f80, 0, 0, 0, 0, 0
.short 0, 0, 0, 0x3f80, 0, 0, 0, 0
.short 0, 0, 0, 0, 0x3f80, 0, 0, 0
.short 0, 0, 0, 0, 0, 0x3f80, 0, 0
.short 0, 0, 0, 0, 0, 0, 0x3f80, 0
.short 0, 0, 0, 0, 0, 0, 0, 0x3f80
.short 0, 0, 0, 0, 0, 0, 0, 0
.short 0, 0, 0, 0, 0, 0, 0, 0
.short 0, 0, 0, 0, 0, 0, 0, 0
.short 0, 0, 0, 0, 0, 0, 0, 0
.short 0, 0, 0, 0, 0, 0, 0, 0
.short 0, 0, 0, 0, 0, 0, 0, 0
.short 0, 0, 0, 0, 0, 0, 0, 0
.short 0, 0, 0, 0, 0, 0, 0, 0
.short 0, 0, 0, 0, 0, 0, 0, 0
.short 0, 0, 0, 0, 0, 0, 0, 0
.short 0, 0, 0, 0, 0, 0, 0, 0
.short 0, 0, 0, 0, 0, 0, 0, 0
.short 0, 0, 0, 0, 0, 0, 0, 0
.short 0, 0, 0, 0, 0, 0, 0, 0
.short 0, 0, 0, 0, 0, 0, 0, 0
.short 0, 0, 0, 0, 0, 0, 0, 0
.short 0x3f80, 0, 0, 0, 0, 0, 0, 0
.short 0, 0x3f80, 0, 0, 0, 0, 0, 0
.short 0, 0, 0x3f80, 0, 0, 0, 0, 0
.short 0, 0, 0, 0x3f80, 0, 0, 0, 0
.short 0, 0, 0, 0, 0x3f80, 0, 0, 0
.short 0, 0, 0, 0, 0, 0x3f80, 0, 0
.short 0, 0, 0, 0, 0, 0, 0x3f80, 0
.short 0, 0, 0, 0, 0, 0, 0, 0x3f80
.size tail_table, 1536
.type tap_table,@object
tap_table:
.short 4188, 976, 848, 0, 0, 0, 0, 0
.short 28, 1024, 912, 16, 128, 4, 64, 16
.short 4184, 1088, 976, 896, 256, 1792, 128, 32
.short 24, 1152, 1024, 912, 384, 1796, 192, 48
.short 4180, 1216, 1088, 1792, 512, 3584, 272, 64
.short 20, 1296, 1152, 1808, 640, 3588, 336, 80
.short 4176, 1360, 1216, 2688, 768, 5376, 400, 96
.short 16, 1424, 1296, 2704, 896, 5380, 464, 112
.short 4172, 1488, 1360, 3584, 1024, 7168, 512, 132
.short 12, 1536, 1424, 3600, 1152, 7172, 576, 148
.short 4168, 1600, 1488, 4480, 1280, 8960, 640, 164
.short 8, 1664, 1536, 4496, 1408, 8964, 704, 180
.short 4164, 1728, 1600, 5376, 1536, 10752, 784, 196
.short 4, 1808, 1664, 5392, 1664, 10756, 848, 212
.short 4160, 1872, 1728, 6272, 1792, 12544, 912, 228
.short 0, 1936, 1808, 6288, 1920, 12548, 976, 244
.short 4204, 1008, 880, 7184, 32, 1, 8, 1032
.short 44, 1056, 944, 7168, 160, 5, 72, 1048
.short 4200, 1120, 1008, 8080, 288, 1793, 136, 1064
.short 40, 1184, 1056, 8064, 416, 1797, 200, 1080
.short 4196, 1248, 1120, 8976, 544, 3585, 280, 1096
.short 36, 1328, 1184, 8960, 672, 3589, 344, 1112
.short 4192, 1392, 1248, 9872, 800, 5377, 408, 1128
.short 32, 1456, 1328, 9856, 928, 5381, 472, 1144
.short 4188, 1520, 1392, 10768, 1056, 7169, 520, 1164
.short 28, 1568, 1456, 10752, 1184, 7173, 584, 1180
.short 4184, 1632, 1520, 11664, 1312, 8961, 648, 1196
.short 24, 1696, 1568, 11648, 1440, 8965, 712, 1212
.short 4180, 1760, 1632, 12560, 1568, 10753, 792, 1228
.short 20, 1840, 1696, 12544, 1696, 10757, 856, 1244
.short 4176, 1904, 1760, 13456, 1824, 12545, 920, 1260
.short 16, 1968, 1840, 13440, 1952, 12549, 984, 1276
.short 4220, 1024, 912, 14336, 64, 2, 32, 2048
.short 60, 1088, 976, 14352, 192, 6, 96, 2064
.short 4216, 1152, 1024, 15232, 320, 1794, 160, 2080
.short 56, 1216, 1088, 15248, 448, 1798, 224, 2096
.short 4212, 1296, 1152, 16128, 576, 3586, 304, 2112
.short 52, 1360, 1216, 16144, 704, 3590, 368, 2128
.short 4208, 1424, 1296, 17024, 832, 5378, 432, 2144
.short 48, 1488, 1360, 17040, 960, 5382, 496, 2160
.short 4204, 1536, 1424, 17920, 1088, 7170, 544, 2180
.short 44, 1600, 1488, 17936, 1216, 7174, 608, 2196
.short 4200, 1664, 1536, 18816, 1344, 8962, 672, 2212
.short 40, 1728, 1600, 18832, 1472, 8966, 736, 2228
.short 4196, 1808, 1664, 19712, 1600, 10754, 816, 2244
.short 36, 1872, 1728, 19728, 1728, 10758, 880, 2260
.short 4192, 1936, 1808, 20608, 1856, 12546, 944, 2276
.short 32, 2000, 1872, 20624, 1984, 12550, 1008, 2292
.short 4236, 1056, 944, 21520, 96, 3, 40, 3080
.short 76, 1120, 1008, 21504, 224, 7, 104, 3096
.short 4232, 1184, 1056, 22416, 352, 1795, 168, 3112
.short 72, 1248, 1120, 22400, 480, 1799, 232, 3128
.short 4228, 1328, 1184, 23312, 608, 3587, 312, 3144
.short 68, 1392, 1248, 23296, 736, 3591, 376, 3160
.short 4224, 1456, 1328, 24208, 864, 5379, 440, 3176
.short 64, 1520, 1392, 24192, 992, 5383, 504, 3192
.short 4220, 1568, 1456, 25104, 1120, 7171, 552, 3212
.short 60, 1632, 1520, 25088, 1248, 7175, 616, 3228
.short 4216, 1696, 1568, 26000, 1376, 8963, 680, 3244
.short 56, 1760, 1632, 25984, 1504, 8967, 744, 3260
.short 4212, 1840, 1696, 26896, 1632, 10755, 824, 3276
.short 52, 1904, 1760, 26880, 1760, 10759, 888, 3292
.short 4208, 1968, 1840, 27792, 1888, 12547, 952, 3308
.short 48, 2032, 1904, 27776, 2016, 12551, 1016, 3324
.short 0, 0, 0, 0, 0, 0, 0, 0
.short 288, 8, 16, 16, 16, 8, 16, 14
.short 576, 16, 8, 32, 32, 16, 0, 28
.short 864, 24, 24, 48, 48, 24, 16, 42
.short 1152, 64, 64, 896, 3584, 960, 4160, 56
.short 1440, 72, 80, 912, 3600, 968, 4176, 70
.short 1728, 80, 72, 928, 3616, 976, 4160, 84
.short 2016, 88, 88, 944, 3632, 984, 4176, 98
.short 2304, 128, 128, 1792, 7168, 1920, 8320, 112
.short 2592, 136, 144, 1808, 7184, 1928, 8336, 126
.short 2880, 144, 136, 1824, 7200, 1936, 8320, 140
.short 3168, 152, 152, 1840, 7216, 1944, 8336, 154
.short 3456, 192, 192, 2688, 10752, 2880, 12480, 168
.short 3744, 200, 208, 2704, 10768, 2888, 12496, 182
.short 4032, 208, 200, 2720, 10784, 2896, 12480, 196
.short 4320, 216, 216, 2736, 10800, 2904, 12496, 210
.short 16, 512, 32, 3584, 14336, 32, 0, 224
.short 304, 520, 48, 3600, 14352, 40, 16, 238
.short 592, 528, 40, 3616, 14368, 48, 0, 252
.short 880, 536, 56, 3632, 14384, 56, 16, 266
.short 1168, 576, 96, 4480, 17920, 992, 4160, 280
.short 1456, 584, 112, 4496, 17936, 1000, 4176, 294
.short 1744, 592, 104, 4512, 17952, 1008, 4160, 308
.short 2032, 600, 120, 4528, 17968, 1016, 4176, 322
.short 2320, 640, 160, 5376, 21504, 1952, 8320, 336
.short 2608, 648, 176, 5392, 21520, 1960, 8336, 350
.short 2896, 656, 168, 5408, 21536, 1968, 8320, 364
.short 3184, 664, 184, 5424, 21552, 1976, 8336, 378
.short 3472, 704, 224, 6272, 25088, 2912, 12480, 378
.short 3760, 712, 240, 6288, 25104, 2920, 12496, 378
.short 4048, 720, 232, 6304, 25120, 2928, 12480, 378
.short 4336, 728, 248, 6320, 25136, 2936, 12496, 378
.short 32, 1024, 512, 7168, 28672, 64, 0, 0
.short 320, 1032, 528, 7184, 28688, 72, 16, 14
.short 608, 1040, 520, 7200, 28704, 80, 0, 28
.short 896, 1048, 536, 7216, 28720, 88, 16, 42
.short 1184, 1088, 576, 8064, 32256, 1024, 4160, 56
.short 1472, 1096, 592, 8080, 32272, 1032, 4176, 70
.short 1760, 1104, 584, 8096, 32288, 1040, 4160, 84
.short 2048, 1112, 600, 8112, 32304, 1048, 4176, 98
.short 2336, 1152, 640, 8960, 35840, 1984, 8320, 112
.short 2624, 1160, 656, 8976, 35856, 1992, 8336, 126
.short 2912, 1168, 648, 8992, 35872, 2000, 8320, 140
.short 3200, 1176, 664, 9008, 35888, 2008, 8336, 154
.short 3488, 1216, 704, 9856, 39424, 2944, 12480, 168
.short 3776, 1224, 720, 9872, 39440, 2952, 12496, 182
.short 4064, 1232, 712, 9888, 39456, 2960, 12480, 196
.short 4352, 1240, 728, 9904, 39472, 2968, 12496, 210
.short 48, 1536, 544, 10752, 43008, 96, 0, 224
.short 336, 1544, 560, 10768, 43024, 104, 16, 238
.short 624, 1552, 552, 10784, 43040, 112, 0, 252
.short 912, 1560, 568, 10800, 43056, 120, 16, 266
.short 1200, 1600, 608, 11648, 46592, 1056, 4160, 280
.short 1488, 1608, 624, 11664, 46608, 1064, 4176, 294
.short 1776, 1616, 616, 11680, 46624, 1072, 4160, 308
.short 2064, 1624, 632, 11696, 46640, 1080, 4176, 322
.short 2352, 1664, 672, 12544, 50176, 2016, 8320, 336
.short 2640, 1672, 688, 12560, 50192, 2024, 8336, 350
.short 2928, 1680, 680, 12576, 50208, 2032, 8320, 364
.short 3216, 1688, 696, 12592, 50224, 2040, 8336, 378
.short 3504, 1728, 736, 13440, 53760, 2976, 12480, 378
.short 3792, 1736, 752, 13456, 53776, 2984, 12496, 378
.short 4080, 1744, 744, 13472, 53792, 2992, 12480, 378
.short 4368, 1752, 760, 13488, 53808, 3000, 12496, 378
.short 4080, 4080, 4080, 4080, 4064, 4064, 4064, 4064
.short 4064, 4064, 4064, 4048, 4048, 4048, 4048, 4048
.short 4048, 4048, 4048, 4048, 4032, 4032, 4032, 4032
.short 4032, 4032, 4032, 4016, 4016, 4016, 4016, 4016
.short 4016, 4016, 4016, 4016, 4000, 4000, 4000, 4000
.short 4000, 4000, 4000, 3984, 3984, 3984, 3984, 3984
.short 3984, 3984, 3984, 3984, 3968, 3968, 3968, 3968
.short 3968, 3968, 3968, 3952, 3952, 3952, 3952, 3952
.short 3952, 3952, 3952, 3952, 3936, 3936, 3936, 3936
.short 3936, 3936, 3936, 3920, 3920, 3920, 3920, 3920
.short 3920, 3920, 3920, 3920, 3904, 3904, 3904, 3904
.short 3904, 3904, 3904, 3888, 3888, 3888, 3888, 3888
.short 3888, 3888, 3888, 3888, 3872, 3872, 3872, 3872
.short 3872, 3872, 3872, 3856, 3856, 3856, 3856, 3856
.short 3856, 3856, 3856, 3856, 3840, 3840, 3840, 3840
.short 3840, 3840, 3840, 3824, 3824, 3824, 3824, 3824
.short 3824, 3824, 3824, 3824, 3808, 3808, 3808, 3808
.short 3808, 3808, 3808, 3792, 3792, 3792, 3792, 3792
.short 3792, 3792, 3792, 3792, 3776, 3776, 3776, 3776
.short 3776, 3776, 3776, 3760, 3760, 3760, 3760, 3760
.short 3760, 3760, 3760, 3760, 3744, 3744, 3744, 3744
.short 3744, 3744, 3744, 3728, 3728, 3728, 3728, 3728
.short 3728, 3728, 3728, 3728, 3712, 3712, 3712, 3712
.short 3712, 3712, 3712, 3696, 3696, 3696, 3696, 3696
.short 3696, 3696, 3696, 3696, 3680, 3680, 3680, 3680
.short 3680, 3680, 3680, 3664, 3664, 3664, 3664, 3664
.short 3664, 3664, 3664, 3664, 3648, 3648, 3648, 3648
.short 3648, 3648, 3648, 3632, 3632, 3632, 3632, 3632
.short 3632, 3632, 3632, 3632, 3616, 3616, 3616, 3616
.short 3616, 3616, 3616, 3600, 3600, 3600, 3600, 3600
.short 3600, 3600, 3600, 3600, 3584, 3584, 3584, 3584
.short 3584, 3584, 3584, 3568, 3568, 3568, 3568, 3568
.short 3568, 3568, 3568, 3568, 3552, 3552, 3552, 3552
.short 3552, 3552, 3552, 3536, 3536, 3536, 3536, 3536
.short 3536, 3536, 3536, 3536, 3520, 3520, 3520, 3520
.short 3520, 3520, 3520, 3504, 3504, 3504, 3504, 3504
.short 3504, 3504, 3504, 3504, 3488, 3488, 3488, 3488
.short 3488, 3488, 3488, 3472, 3472, 3472, 3472, 3472
.short 3472, 3472, 3472, 3472, 3456, 3456, 3456, 3456
.short 3456, 3456, 3456, 3440, 3440, 3440, 3440, 3440
.short 3440, 3440, 3440, 3440, 3424, 3424, 3424, 3424
.short 3424, 3424, 3424, 3408, 3408, 3408, 3408, 3408
.short 3408, 3408, 3408, 3408, 3392, 3392, 3392, 3392
.short 3392, 3392, 3392, 3376, 3376, 3376, 3376, 3376
.short 3376, 3376, 3376, 3376, 3360, 3360, 3360, 3360
.short 3360, 3360, 3360, 3344, 3344, 3344, 3344, 3344
.short 3344, 3344, 3344, 3344, 3328, 3328, 3328, 3328
.short 3328, 3328, 3328, 3312, 3312, 3312, 3312, 3312
.short 3312, 3312, 3312, 3312, 3296, 3296, 3296, 3296
.short 3296, 3296, 3296, 3280, 3280, 3280, 3280, 3280
.short 3280, 3280, 3280, 3280, 3264, 3264, 3264, 3264
.short 3264, 3264, 3264, 3248, 3248, 3248, 3248, 3248
.short 3248, 3248, 3248, 3248, 3232, 3232, 3232, 3232
.short 3232, 3232, 3232, 3216, 3216, 3216, 3216, 3216
.short 3216, 3216, 3216, 3216, 3200, 3200, 3200, 3200
.short 3200, 3200, 3200, 3184, 3184, 3184, 3184, 3184
.short 3184, 3184, 3184, 3184, 3168, 3168, 3168, 3168
.short 3168, 3168, 3168, 3152, 3152, 3152, 3152, 3152
.short 3152, 3152, 3152, 3152, 3136, 3136, 3136, 3136
.short 3136, 3136, 3136, 3120, 3120, 3120, 3120, 3120
.short 3120, 3120, 3120, 3120, 3104, 3104, 3104, 3104
.short 3104, 3104, 3104, 3088, 3088, 3088, 3088, 3088
.short 3088, 3088, 3088, 3088, 3072, 3072, 3072, 3072
.short 3072, 3072, 3072, 3056, 3056, 3056, 3056, 3056
.short 3056, 3056, 3056, 3056, 3040, 3040, 3040, 3040
.short 3040, 3040, 3040, 3024, 3024, 3024, 3024, 3024
.short 3024, 3024, 3024, 3024, 3008, 3008, 3008, 3008
.short 3008, 3008, 3008, 2992, 2992, 2992, 2992, 2992
.short 2992, 2992, 2992, 2992, 2976, 2976, 2976, 2976
.short 2976, 2976, 2976, 2960, 2960, 2960, 2960, 2960
.short 2960, 2960, 2960, 2960, 2944, 2944, 2944, 2944
.short 2944, 2944, 2944, 2928, 2928, 2928, 2928, 2928
.short 2928, 2928, 2928, 2928, 2912, 2912, 2912, 2912
.short 2912, 2912, 2912, 2896, 2896, 2896, 2896, 2896
.short 2896, 2896, 2896, 2896, 2880, 2880, 2880, 2880
.short 2880, 2880, 2880, 2864, 2864, 2864, 2864, 2864
.short 2864, 2864, 2864, 2864, 2848, 2848, 2848, 2848
.short 2848, 2848, 2848, 2832, 2832, 2832, 2832, 2832
.short 2832, 2832, 2832, 2832, 2816, 2816, 2816, 2816
.short 2816, 2816, 2816, 2800, 2800, 2800, 2800, 2800
.short 2800, 2800, 2800, 2800, 2784, 2784, 2784, 2784
.short 2784, 2784, 2784, 2768, 2768, 2768, 2768, 2768
.short 2768, 2768, 2768, 2768, 2752, 2752, 2752, 2752
.short 2752, 2752, 2752, 2736, 2736, 2736, 2736, 2736
.short 2736, 2736, 2736, 2736, 2720, 2720, 2720, 2720
.short 2720, 2720, 2720, 2704, 2704, 2704, 2704, 2704
.short 2704, 2704, 2704, 2704, 2688, 2688, 2688, 2688
.short 2688, 2688, 2688, 2672, 2672, 2672, 2672, 2672
.short 2672, 2672, 2672, 2672, 2656, 2656, 2656, 2656
.short 2656, 2656, 2656, 2640, 2640, 2640, 2640, 2640
.short 2640, 2640, 2640, 2640, 2624, 2624, 2624, 2624
.short 2624, 2624, 2624, 2608, 2608, 2608, 2608, 2608
.short 2608, 2608, 2608, 2608, 2592, 2592, 2592, 2592
.short 2592, 2592, 2592, 2576, 2576, 2576, 2576, 2576
.short 2576, 2576, 2576, 2576, 2560, 2560, 2560, 2560
.short 2560, 2560, 2560, 2544, 2544, 2544, 2544, 2544
.short 2544, 2544, 2544, 2544, 2528, 2528, 2528, 2528
.short 2528, 2528, 2528, 2512, 2512, 2512, 2512, 2512
.short 2512, 2512, 2512, 2512, 2496, 2496, 2496, 2496
.short 2496, 2496, 2496, 2480, 2480, 2480, 2480, 2480
.short 2480, 2480, 2480, 2480, 2464, 2464, 2464, 2464
.short 2464, 2464, 2464, 2448, 2448, 2448, 2448, 2448
.short 2448, 2448, 2448, 2448, 2432, 2432, 2432, 2432
.short 2432, 2432, 2432, 2416, 2416, 2416, 2416, 2416
.short 2416, 2416, 2416, 2416, 2400, 2400, 2400, 2400
.short 2400, 2400, 2400, 2384, 2384, 2384, 2384, 2384
.short 2384, 2384, 2384, 2384, 2368, 2368, 2368, 2368
.short 2368, 2368, 2368, 2352, 2352, 2352, 2352, 2352
.short 2352, 2352, 2352, 2352, 2336, 2336, 2336, 2336
.short 2336, 2336, 2336, 2320, 2320, 2320, 2320, 2320
.short 2320, 2320, 2320, 2320, 2304, 2304, 2304, 2304
.short 2304, 2304, 2304, 2288, 2288, 2288, 2288, 2288
.short 2288, 2288, 2288, 2288, 2272, 2272, 2272, 2272
.short 2272, 2272, 2272, 2256, 2256, 2256, 2256, 2256
.short 2256, 2256, 2256, 2256, 2240, 2240, 2240, 2240
.short 2240, 2240, 2240, 2224, 2224, 2224, 2224, 2224
.short 2224, 2224, 2224, 2224, 2208, 2208, 2208, 2208
.short 2208, 2208, 2208, 2192, 2192, 2192, 2192, 2192
.short 2192, 2192, 2192, 2192, 2176, 2176, 2176, 2176
.short 2176, 2176, 2176, 2160, 2160, 2160, 2160, 2160
.short 2160, 2160, 2160, 2160, 2144, 2144, 2144, 2144
.short 2144, 2144, 2144, 2128, 2128, 2128, 2128, 2128
.short 2128, 2128, 2128, 2128, 2112, 2112, 2112, 2112
.short 2112, 2112, 2112, 2096, 2096, 2096, 2096, 2096
.short 2096, 2096, 2096, 2096, 2080, 2080, 2080, 2080
.short 2080, 2080, 2080, 2064, 2064, 2064, 2064, 2064
.short 2064, 2064, 2064, 2064, 2048, 2048, 2048, 2048
.short 2048, 2048, 2048, 2032, 2032, 2032, 2032, 2032
.short 2032, 2032, 6128, 6128, 6128, 2016, 2016, 2016
.short 2016, 2016, 6112, 6112, 6112, 2000, 2000, 2000
.short 2000, 2000, 6096, 6096, 6096, 1984, 1984, 1984
.short 1984, 1984, 6080, 6080, 6080, 1968, 1968, 1968
.short 1968, 1968, 6064, 6064, 6064, 1952, 1952, 1952
.short 1952, 1952, 6048, 6048, 6048, 1936, 1936, 1936
.short 1936, 1936, 6032, 6032, 6032, 1920, 1920, 1920
.short 1920, 1920, 6016, 6016, 6016, 1904, 1904, 1904
.short 1904, 1904, 6000, 6000, 6000, 1888, 1888, 1888
.short 1888, 1888, 5984, 5984, 5984, 1872, 1872, 1872
.short 1872, 1872, 5968, 5968, 5968, 1856, 1856, 1856
.short 1856, 1856, 5952, 5952, 5952, 1840, 1840, 1840
.short 1840, 1840, 5936, 5936, 5936, 1824, 1824, 1824
.short 1824, 1824, 5920, 5920, 5920, 1808, 1808, 1808
.short 1808, 1808, 5904, 5904, 5904, 1792, 1792, 1792
.short 1792, 1792, 5888, 5888, 5888, 1776, 1776, 1776
.short 1776, 1776, 5872, 5872, 5872, 1760, 1760, 1760
.short 1760, 1760, 5856, 5856, 5856, 1744, 1744, 1744
.short 1744, 1744, 5840, 5840, 5840, 1728, 1728, 1728
.short 1728, 1728, 5824, 5824, 5824, 1712, 1712, 1712
.short 1712, 1712, 5808, 5808, 5808, 1696, 1696, 1696
.short 1696, 1696, 5792, 5792, 5792, 1680, 1680, 1680
.short 1680, 1680, 5776, 5776, 5776, 1664, 1664, 1664
.short 1664, 1664, 5760, 5760, 5760, 1648, 1648, 1648
.short 1648, 1648, 5744, 5744, 5744, 1632, 1632, 1632
.short 1632, 1632, 5728, 5728, 5728, 1616, 1616, 1616
.short 1616, 1616, 5712, 5712, 5712, 1600, 1600, 1600
.short 1600, 1600, 5696, 5696, 5696, 1584, 1584, 1584
.short 1584, 1584, 5680, 5680, 5680, 1568, 1568, 1568
.short 1568, 1568, 5664, 5664, 5664, 1552, 1552, 1552
.short 1552, 1552, 5648, 5648, 5648, 1536, 1536, 1536
.short 1536, 1536, 5632, 5632, 5632, 1520, 1520, 1520
.short 1520, 1520, 5616, 5616, 5616, 1504, 1504, 1504
.short 1504, 1504, 5600, 5600, 5600, 1488, 1488, 1488
.short 1488, 1488, 5584, 5584, 5584, 1472, 1472, 1472
.short 1472, 1472, 5568, 5568, 5568, 1456, 1456, 1456
.short 1456, 1456, 5552, 5552, 5552, 1440, 1440, 1440
.short 1440, 1440, 5536, 5536, 5536, 1424, 1424, 1424
.short 1424, 1424, 5520, 5520, 5520, 1408, 1408, 1408
.short 1408, 1408, 5504, 5504, 5504, 1392, 1392, 1392
.short 1392, 1392, 5488, 5488, 5488, 1376, 1376, 1376
.short 1376, 1376, 5472, 5472, 5472, 1360, 1360, 1360
.short 1360, 1360, 5456, 5456, 5456, 1344, 1344, 1344
.short 1344, 1344, 5440, 5440, 5440, 1328, 1328, 1328
.short 1328, 1328, 5424, 5424, 5424, 1312, 1312, 1312
.short 1312, 1312, 5408, 5408, 5408, 1296, 1296, 1296
.short 1296, 1296, 5392, 5392, 5392, 1280, 1280, 1280
.short 1280, 1280, 5376, 5376, 5376, 1264, 1264, 1264
.short 1264, 1264, 5360, 5360, 5360, 1248, 1248, 1248
.short 1248, 1248, 5344, 5344, 5344, 1232, 1232, 1232
.short 1232, 1232, 5328, 5328, 5328, 1216, 1216, 1216
.short 1216, 1216, 5312, 5312, 5312, 1200, 1200, 1200
.short 1200, 1200, 5296, 5296, 5296, 1184, 1184, 1184
.short 1184, 1184, 5280, 5280, 5280, 1168, 1168, 1168
.short 1168, 1168, 5264, 5264, 5264, 1152, 1152, 1152
.short 1152, 1152, 5248, 5248, 5248, 1136, 1136, 1136
.short 1136, 1136, 5232, 5232, 5232, 1120, 1120, 1120
.short 1120, 1120, 5216, 5216, 5216, 1104, 1104, 1104
.short 1104, 1104, 5200, 5200, 5200, 1088, 1088, 1088
.short 1088, 1088, 5184, 5184, 5184, 1072, 1072, 1072
.short 1072, 1072, 5168, 5168, 5168, 1056, 1056, 1056
.short 1056, 1056, 5152, 5152, 5152, 1040, 1040, 1040
.short 1040, 1040, 5136, 5136, 5136, 1024, 1024, 1024
.short 1024, 1024, 5120, 5120, 5120, 1008, 1008, 1008
.short 1008, 8176, 5104, 5104, 5104, 7152, 992, 992
.short 992, 8160, 5088, 5088, 5088, 7136, 976, 976
.short 976, 8144, 5072, 5072, 5072, 7120, 960, 960
.short 960, 8128, 5056, 5056, 5056, 7104, 944, 944
.short 944, 8112, 5040, 5040, 5040, 7088, 928, 928
.short 928, 8096, 5024, 5024, 5024, 7072, 912, 912
.short 912, 8080, 5008, 5008, 5008, 7056, 896, 896
.short 896, 8064, 4992, 4992, 4992, 7040, 880, 880
.short 880, 8048, 4976, 4976, 4976, 7024, 864, 864
.short 864, 8032, 4960, 4960, 4960, 7008, 848, 848
.short 848, 8016, 4944, 4944, 4944, 6992, 832, 832
.short 832, 8000, 4928, 4928, 4928, 6976, 816, 816
.short 816, 7984, 4912, 4912, 4912, 6960, 800, 800
.short 800, 7968, 4896, 4896, 4896, 6944, 784, 784
.short 784, 7952, 4880, 4880, 4880, 6928, 768, 768
.short 768, 7936, 4864, 4864, 4864, 6912, 752, 752
.short 752, 7920, 4848, 4848, 4848, 6896, 736, 736
.short 736, 7904, 4832, 4832, 4832, 6880, 720, 720
.short 720, 7888, 4816, 4816, 4816, 6864, 704, 704
.short 704, 7872, 4800, 4800, 4800, 6848, 688, 688
.short 688, 7856, 4784, 4784, 4784, 6832, 672, 672
.short 672, 7840, 4768, 4768, 4768, 6816, 656, 656
.short 656, 7824, 4752, 4752, 4752, 6800, 640, 640
.short 640, 7808, 4736, 4736, 4736, 6784, 624, 624
.short 624, 7792, 4720, 4720, 4720, 6768, 608, 608
.short 608, 7776, 4704, 4704, 4704, 6752, 592, 592
.short 592, 7760, 4688, 4688, 4688, 6736, 576, 576
.short 576, 7744, 4672, 4672, 4672, 6720, 560, 560
.short 560, 7728, 4656, 4656, 4656, 6704, 544, 544
.short 544, 7712, 4640, 4640, 4640, 6688, 528, 528
.short 528, 7696, 4624, 4624, 4624, 6672, 512, 512
.short 512, 7680, 4608, 4608, 4608, 6656, 496, 496
.short 10224, 7664, 9712, 4592, 9200, 6640, 8688, 480
.short 10208, 7648, 9696, 4576, 9184, 6624, 8672, 464
.short 10192, 7632, 9680, 4560, 9168, 6608, 8656, 448
.short 10176, 7616, 9664, 4544, 9152, 6592, 8640, 432
.short 10160, 7600, 9648, 4528, 9136, 6576, 8624, 416
.short 10144, 7584, 9632, 4512, 9120, 6560, 8608, 400
.short 10128, 7568, 9616, 4496, 9104, 6544, 8592, 384
.short 10112, 7552, 9600, 4480, 9088, 6528, 8576, 368
.short 10096, 7536, 9584, 4464, 9072, 6512, 8560, 352
.short 10080, 7520, 9568, 4448, 9056, 6496, 8544, 336
.short 10064, 7504, 9552, 4432, 9040, 6480, 8528, 320
.short 10048, 7488, 9536, 4416, 9024, 6464, 8512, 304
.short 10032, 7472, 9520, 4400, 9008, 6448, 8496, 288
.short 10016, 7456, 9504, 4384, 8992, 6432, 8480, 272
.short 10000, 7440, 9488, 4368, 8976, 6416, 8464, 256
.short 9984, 7424, 9472, 4352, 8960, 6400, 8448, 240
.short 9968, 7408, 9456, 4336, 8944, 6384, 8432, 224
.short 9952, 7392, 9440, 4320, 8928, 6368, 8416, 208
.short 9936, 7376, 9424, 4304, 8912, 6352, 8400, 192
.short 9920, 7360, 9408, 4288, 8896, 6336, 8384, 176
.short 9904, 7344, 9392, 4272, 8880, 6320, 8368, 160
.short 9888, 7328, 9376, 4256, 8864, 6304, 8352, 144
.short 9872, 7312, 9360, 4240, 8848, 6288, 8336, 128
.short 9856, 7296, 9344, 4224, 8832, 6272, 8320, 112
.short 9840, 7280, 9328, 4208, 8816, 6256, 8304, 96
.short 9824, 7264, 9312, 4192, 8800, 6240, 8288, 80
.short 9808, 7248, 9296, 4176, 8784, 6224, 8272, 64
.short 9792, 7232, 9280, 4160, 8768, 6208, 8256, 48
.short 9776, 7216, 9264, 4144, 8752, 6192, 8240, 32
.short 9760, 7200, 9248, 4128, 8736, 6176, 8224, 16
.short 9744, 7184, 9232, 4112, 8720, 6160, 8208, 0
.short 9728, 7168, 9216, 4096, 8704, 6144, 8192, 10240
.short 12288, 12288, 12288, 12288, 12288, 12288, 12288, 12288
.short 0, 0, 0, 0, 0, 0, 0, 0
.short 0, 0, 0, 0, 0, 0, 0, 0
.short 0, 0, 0, 0, 0, 0, 0, 0
.short 0, 0, 0, 0, 0, 0, 0, 0
.short 0, 0, 0, 0, 0, 0, 0, 0
.short 0, 0, 0, 0, 0, 0, 0, 0
.short 0, 0, 0, 0, 0, 0, 0, 0
.long 0, 917504, 16892160, 34210300, 33784320, 66388980, 34245120, 125634428
.long 34817024, 82248934, 50532736, 173410888, 51049088, 203033616, 51593216, 232263116
.long 57600, 8388722, 16949760, 41681518, 33786368, 125110132, 34358272, 81724638
.long 34819072, 140970086, 50590336, 177212036, 51134464, 206441536, 51650816, 236064264
.long 115200, 15859940, 17007360, 49152736, 33899520, 81200342, 34360320, 140445790
.long 34932224, 97060296, 50675712, 168233470, 51192064, 210242684, 51708416, 239865412
.long 172800, 23331158, 17092736, 30998987, 33901568, 139921494, 34473472, 96536000
.long 35045376, 53150506, 50733312, 184421104, 51249664, 214043832, 51766016, 256053046
.long 258176, 5177409, 17150336, 38470205, 34014720, 96011704, 34586624, 52626210
.long 35047424, 111871658, 50790912, 188222252, 51307264, 217844980, 51851392, 247074480
.long 315776, 12648627, 33555968, 95487408, 34127872, 52101914, 34588672, 111347362
.long 50332160, 162400672, 50848512, 192023400, 51392640, 221252900, 51908992, 250875628
.long 373376, 20119845, 33669120, 51577618, 34129920, 110823066, 34701824, 67437572
.long 50389760, 166201820, 50933888, 195431320, 51450240, 225054048, 67108864, 0
.long 16834560, 26739082, 33671168, 110298770, 34243072, 66913276, 34703872, 126158724
.long 50475136, 157223254, 50991488, 199232468, 51507840, 228855196, 67108864, 0
.long 64, 2752540, 16892224, 36045336, 33784384, 68224016, 34245184, 127469464
.long 34817088, 84083970, 50532800, 173869641, 51049152, 203492369, 51593280, 232721869
.long 57664, 10223758, 16949824, 43516554, 33786432, 126945168, 34358336, 83559674
.long 34819136, 142805122, 50590400, 177670789, 51134528, 206900289, 51650880, 236523017
.long 115264, 17694976, 17007424, 50987772, 33899584, 83035378, 34360384, 142280826
.long 34932288, 98895332, 50675776, 168692223, 51192128, 210701437, 51708480, 240324165
.long 172864, 25166194, 17092800, 32834023, 33901632, 141756530, 34473536, 98371036
.long 35045440, 54985542, 50733376, 184879857, 51249728, 214502585, 51766080, 256511799
.long 258240, 7012445, 17150400, 40305241, 34014784, 97846740, 34586688, 54461246
.long 35047488, 113706694, 50790976, 188681005, 51307328, 218303733, 51851456, 247533233
.long 315840, 14483663, 33556032, 97322444, 34127936, 53936950, 34588736, 113182398
.long 50332224, 162859425, 50848576, 192482153, 51392704, 221711653, 51909056, 251334381
.long 373440, 21954881, 33669184, 53412654, 34129984, 112658102, 34701888, 69272608
.long 50389824, 166660573, 50933952, 195890073, 51450304, 225512801, 67108864, 0
.long 16834624, 28574118, 33671232, 112133806, 34243136, 68748312, 34703936, 127993760
.long 50475200, 157682007, 50991552, 199691221, 51507904, 229313949, 67108864, 0
.long 128, 4587576, 16892288, 37880372, 33784448, 70059052, 34245248, 129304500
.long 34817152, 85919006, 50532864, 175245924, 51049216, 204868652, 51593344, 234098152
.long 57728, 12058794, 16949888, 45351590, 33786496, 128780204, 34358400, 85394710
.long 34819200, 144640158, 50590464, 179047072, 51134592, 208276572, 51650944, 237899300
.long 115328, 19530012, 17035264, 27197841, 33899648, 84870414, 34360448, 144115862
.long 34932352, 100730368, 50675840, 170068506, 51192192, 212077720, 51708544, 241700448
.long 200704, 1376263, 17092864, 34669059, 33901696, 143591566, 34473600, 100206072
.long 35045504, 56820578, 50733440, 186256140, 51249792, 215878868, 51793920, 245108368
.long 258304, 8847481, 17150464, 42140277, 34014848, 99681776, 34586752, 56296282
.long 35047552, 115541730, 50791040, 190057288, 51335168, 219286788, 51851520, 248909516
.long 315904, 16318699, 33556096, 99157480, 34128000, 55771986, 34588800, 115017434
.long 50332288, 164235708, 50876416, 181078722, 51392768, 223087936, 51909120, 252710664
.long 373504, 23789917, 33669248, 55247690, 34130048, 114493138, 34701952, 71107644
.long 50417664, 155257142, 50934016, 197266356, 51450368, 226889084, 67108864, 0
.long 16834688, 30409154, 33671296, 113968842, 34243200, 70583348, 34704000, 129828796
.long 50475264, 159058290, 50991616, 201067504, 51507968, 230690232, 67108864, 0
.long 192, 6422612, 16892352, 39715408, 33784512, 71894088, 34245312, 131139536
.long 34817216, 87754042, 50532928, 175704677, 51049280, 205327405, 51593408, 234556905
.long 57792, 13893830, 16949952, 47186626, 33786560, 130615240, 34358464, 87229746
.long 34819264, 146475194, 50590528, 179505825, 51134656, 208735325, 51651008, 238358053
.long 115392, 21365048, 17035328, 29032877, 33899712, 86705450, 34360512, 145950898
.long 34932416, 102565404, 50675904, 170527259, 51192256, 212536473, 51708608, 242159201
.long 200768, 3211299, 17092928, 36504095, 33901760, 145426602, 34473664, 102041108
.long 35045568, 58655614, 50733504, 186714893, 51249856, 216337621, 51793984, 245567121
.long 258368, 10682517, 17150528, 43975313, 34014912, 101516812, 34586816, 58131318
.long 35047616, 117376766, 50791104, 190516041, 51335232, 219745541, 51851584, 249368269
.long 315968, 18153735, 33556160, 100992516, 34128064, 57607022, 34588864, 116852470
.long 50332352, 164694461, 50876480, 181537475, 51392832, 223546689, 51909184, 253169417
.long 373568, 25624953, 33669312, 57082726, 34130112, 116328174, 34702016, 72942680
.long 50417728, 155715895, 50934080, 197725109, 51450432, 227347837, 67108864, 0
.long 16834752, 32244190, 33671360, 115803878, 34243264, 72418384, 34704064, 131663832
.long 50475328, 159517043, 50991680, 201526257, 51508032, 231148985, 67108864, 0
.long 256, 8257648, 16892416, 41550444, 33784576, 73729124, 34245376, 132974572
.long 34817280, 89589078, 50532992, 177080960, 51077120, 193923974, 51593472, 235933188
.long 57856, 15728866, 16950016, 49021662, 33786624, 132450276, 34358528, 89064782
.long 34819328, 148310230, 50618368, 168102394, 51134720, 210111608, 51651072, 239734336
.long 115456, 23200084, 17035392, 30867913, 33899776, 88540486, 34360576, 147785934
.long 34932480, 104400440, 50675968, 171903542, 51192320, 213912756, 51708672, 243535484
.long 200832, 5046335, 17092992, 38339131, 33901824, 147261638, 34473728, 103876144
.long 35045632, 60490650, 50733568, 188091176, 51249920, 217713904, 51794048, 246943404
.long 258432, 12517553, 17150592, 45810349, 34014976, 103351848, 34586880, 59966354
.long 35047680, 119211802, 50791168, 191892324, 51335296, 221121824, 51851648, 250744552
.long 316032, 19988771, 33556224, 102827552, 34128128, 59442058, 34588928, 118687506
.long 50332416, 166070744, 50876544, 182913758, 51392896, 224922972, 51909248, 254545700
.long 16777216, 26608008, 33669376, 58917762, 34130176, 118163210, 34702080, 74777716
.long 50417792, 157092178, 50934144, 199101392, 51450496, 228724120, 67108864, 0
.long 16834816, 34079226, 33671424, 117638914, 34243328, 74253420, 34704128, 133498868
.long 50475392, 160893326, 50991744, 202902540, 51535872, 232132040, 67108864, 0
.long 320, 10092684, 16892480, 43385480, 33784640, 75564160, 34245440, 134809608
.long 34817344, 91424114, 50533056, 177539713, 51077184, 194382727, 51593536, 236391941
.long 57920, 17563902, 16950080, 50856698, 33786688, 134285312, 34358592, 90899818
.long 34819392, 150145266, 50618432, 168561147, 51134784, 210570361, 51651136, 240193089
.long 115520, 25035120, 17035456, 32702949, 33899840, 90375522, 34360640, 149620970
.long 34932544, 106235476, 50676032, 172362295, 51192384, 214371509, 51708736, 243994237
.long 200896, 6881371, 17093056, 40174167, 33901888, 149096674, 34473792, 105711180
.long 35045696, 62325686, 50733632, 188549929, 51249984, 218172657, 51794112, 247402157
.long 258496, 14352589, 17150656, 47645385, 34015040, 105186884, 34586944, 61801390
.long 35047744, 121046838, 50791232, 192351077, 51335360, 221580577, 51851712, 251203305
.long 316096, 21823807, 33556288, 104662588, 34128192, 61277094, 34588992, 120522542
.long 50332480, 166529497, 50876608, 183372511, 51392960, 225381725, 51909312, 255004453
.long 16777280, 28443044, 33669440, 60752798, 34130240, 119998246, 34702144, 76612752
.long 50417856, 157550931, 50934208, 199560145, 51450560, 229182873, 67108864, 0
.long 16834880, 35914262, 33671488, 119473950, 34243392, 76088456, 34704192, 135333904
.long 50475456, 161352079, 50991808, 203361293, 51535936, 232590793, 67108864, 0
.long 384, 11927720, 16892544, 45220516, 33784704, 77399196, 34245504, 136644644
.long 34817408, 93259150, 50533120, 178915996, 51077248, 195759010, 51593600, 237768224
.long 57984, 19398938, 16977920, 27066767, 33786752, 136120348, 34358656, 92734854
.long 34819456, 151980302, 50618496, 169937430, 51134848, 211946644, 51651200, 241569372
.long 143360, 1245189, 17035520, 34537985, 33899904, 92210558, 34360704, 151456006
.long 34932608, 108070512, 50676096, 173738578, 51192448, 215747792, 51736576, 244977292
.long 200960, 8716407, 17093120, 42009203, 33901952, 150931710, 34473856, 107546216
.long 35045760, 64160722, 50733696, 189926212, 51277824, 206769226, 51794176, 248778440
.long 258560, 16187625, 17150720, 49480421, 34015104, 107021920, 34587008, 63636426
.long 35047808, 122881874, 50819072, 180947646, 51335424, 222956860, 51851776, 252579588
.long 316160, 23658843, 33556352, 106497624, 34128256, 63112130, 34589056, 122357578
.long 50360320, 155126066, 50876672, 184748794, 51393024, 226758008, 51909376, 256380736
.long 16777344, 30278080, 33669504, 62587834, 34130304, 121833282, 34702208, 78447788
.long 50417920, 158927214, 50934272, 200936428, 51450624, 230559156, 67108864, 0
.long 16834944, 37749298, 33671552, 121308986, 34243456, 77923492, 34704256, 137168940
.long 50475520, 162728362, 50991872, 204737576, 51536000, 233967076, 67108864, 0
.long 448, 13762756, 16892608, 47055552, 33784768, 79234232, 34245568, 138479680
.long 34817472, 95094186, 50533184, 179374749, 51077312, 196217763, 51593664, 238226977
.long 58048, 21233974, 16977984, 28901803, 33786816, 137955384, 34358720, 94569890
.long 34819520, 153815338, 50618560, 170396183, 51134912, 212405397, 51651264, 242028125
.long 143424, 3080225, 17035584, 36373021, 33899968, 94045594, 34360768, 153291042
.long 34932672, 109905548, 50676160, 174197331, 51192512, 216206545, 51736640, 245436045
.long 201024, 10551443, 17093184, 43844239, 33902016, 152766746, 34473920, 109381252
.long 35045824, 65995758, 50733760, 190384965, 51277888, 207227979, 51794240, 249237193
.long 258624, 18022661, 17150784, 51315457, 34015168, 108856956, 34587072, 65471462
.long 35047872, 124716910, 50819136, 181406399, 51335488, 223415613, 51851840, 253038341
.long 316224, 25493879, 33556416, 108332660, 34128320, 64947166, 34589120, 124192614
.long 50360384, 155584819, 50876736, 185207547, 51393088, 227216761, 51909440, 256839489
.long 16777408, 32113116, 33669568, 64422870, 34130368, 123668318, 34702272, 80282824
.long 50417984, 159385967, 50934336, 201395181, 51450688, 231017909, 67108864, 0
.long 16835008, 39584334, 33671616, 123144022, 34243520, 79758528, 34704320, 139003976
.long 50475584, 163187115, 50991936, 205196329, 51536064, 234425829, 67108864, 0
.long 512, 15597792, 16892672, 48890588, 33784832, 81069268, 34245632, 140314716
.long 34817536, 96929222, 50561024, 167971318, 51077376, 197594046, 51593728, 239603260
.long 58112, 23069010, 16978048, 30736839, 33786880, 139790420, 34358784, 96404926
.long 34930688, 53019432, 50618624, 171772466, 51134976, 213781680, 51651328, 243404408
.long 143488, 4915261, 17035648, 38208057, 33900032, 95880630, 34471936, 52495136
.long 34932736, 111740584, 50676224, 175573614, 51192576, 217582828, 51736704, 246812328
.long 201088, 12386479, 17093248, 45679275, 34013184, 51970840, 34473984, 111216288
.long 35045888, 67830794, 50733824, 191761248, 51277952, 208604262, 51794304, 250613476
.long 258688, 19857697, 33554432, 51446544, 34015232, 110691992, 34587136, 67306498
.long 35047936, 126551946, 50819200, 182782682, 51335552, 224791896, 51851904, 254414624
.long 344064, 1703948, 33556480, 110167696, 34128384, 66782202, 34589184, 126027650
.long 50360448, 156961102, 50876800, 186583830, 51393152, 228593044, 67108864, 0
.long 16777472, 33948152, 33669632, 66257906, 34130432, 125503354, 34702336, 82117860
.long 50418048, 160762250, 50934400, 202771464, 51478528, 219614478, 67108864, 0
.long 16835072, 41419370, 33671680, 124979058, 34243584, 81593564, 34704384, 140839012
.long 50475648, 164563398, 51019776, 193792898, 51536128, 235802112, 67108864, 0
.long 576, 17432828, 16892736, 50725624, 33784896, 82904304, 34245696, 142149752
.long 34817600, 98764258, 50561088, 168430071, 51077440, 198052799, 51593792, 240062013
.long 58176, 24904046, 16978112, 32571875, 33786944, 141625456, 34358848, 98239962
.long 34930752, 54854468, 50618688, 172231219, 51135040, 214240433, 51651392, 243863161
.long 143552, 6750297, 17035712, 40043093, 33900096, 97715666, 34472000, 54330172
.long 34932800, 113575620, 50676288, 176032367, 51192640, 218041581, 51736768, 247271081
.long 201152, 14221515, 17093312, 47514311, 34013248, 53805876, 34474048, 113051324
.long 35045952, 69665830, 50733888, 192220001, 51278016, 209063015, 51794368, 251072229
.long 258752, 21692733, 33554496, 53281580, 34015296, 112527028, 34587200, 69141534
.long 35048000, 128386982, 50819264, 183241435, 51335616, 225250649, 51851968, 254873377
.long 344128, 3538984, 33556544, 112002732, 34128448, 68617238, 34589248, 127862686
.long 50360512, 157419855, 50876864, 187042583, 51393216, 229051797, 67108864, 0
.long 16777536, 35783188, 33669696, 68092942, 34130496, 127338390, 34702400, 83952896
.long 50418112, 161221003, 50934464, 203230217, 51478592, 220073231, 67108864, 0
.long 16835136, 43254406, 33671744, 126814094, 34243648, 83428600, 34704448, 142674048
.long 50475712, 165022151, 51019840, 194251651, 51536192, 236260865, 67108864, 0
.long 640, 19267864, 16920576, 26935693, 33784960, 84739340, 34245760, 143984788
.long 34817664, 100599294, 50561152, 169806354, 51077504, 199429082, 51593856, 241438296
.long 86016, 1114115, 16978176, 34406911, 33787008, 143460492, 34358912, 100074998
.long 34930816, 56689504, 50618752, 173607502, 51135104, 215616716, 51679232, 232459730
.long 143616, 8585333, 17035776, 41878129, 33900160, 99550702, 34472064, 56165208
.long 34932864, 115410656, 50676352, 177408650, 51220480, 206638150, 51736832, 248647364
.long 201216, 16056551, 17093376, 49349347, 34013312, 55640912, 34474112, 114886360
.long 35046016, 71500866, 50761728, 180816570, 51278080, 210439298, 51794432, 252448512
.long 258816, 23527769, 33554560, 55116616, 34015360, 114362064, 34587264, 70976570
.long 35048064, 130222018, 50819328, 184617718, 51335680, 226626932, 51852032, 256249660
.long 344192, 5374020, 33556608, 113837768, 34128512, 70452274, 34589312, 129697722
.long 50360576, 158796138, 50876928, 188418866, 51393280, 230428080, 67108864, 0
.long 16777600, 37618224, 33669760, 69927978, 34130560, 129173426, 34702464, 85787932
.long 50418176, 162597286, 50934528, 204606500, 51478656, 221449514, 67108864, 0
.long 16835200, 45089442, 33671808, 128649130, 34243712, 85263636, 34704512, 144509084
.long 50475776, 166398434, 51019904, 195627934, 51536256, 237637148, 67108864, 0
.long 704, 21102900, 16920640, 28770729, 33785024, 86574376, 34245824, 145819824
.long 34817728, 102434330, 50561216, 170265107, 51077568, 199887835, 51593920, 241897049
.long 86080, 2949151, 16978240, 36241947, 33787072, 145295528, 34358976, 101910034
.long 34930880, 58524540, 50618816, 174066255, 51135168, 216075469, 51679296, 232918483
.long 143680, 10420369, 17035840, 43713165, 33900224, 101385738, 34472128, 58000244
.long 34932928, 117245692, 50676416, 177867403, 51220544, 207096903, 51736896, 249106117
.long 201280, 17891587, 17093440, 51184383, 34013376, 57475948, 34474176, 116721396
.long 35046080, 73335902, 50761792, 181275323, 51278144, 210898051, 51794496, 252907265
.long 258880, 25362805, 33554624, 56951652, 34015424, 116197100, 34587328, 72811606
.long 35048128, 132057054, 50819392, 185076471, 51335744, 227085685, 51852096, 256708413
.long 344256, 7209056, 33556672, 115672804, 34128576, 72287310, 34589376, 131532758
.long 50360640, 159254891, 50876992, 188877619, 51393344, 230886833, 67108864, 0
.long 16777664, 39453260, 33669824, 71763014, 34130624, 131008462, 34702528, 87622968
.long 50418240, 163056039, 50934592, 205065253, 51478720, 221908267, 67108864, 0
.long 16835264, 46924478, 33671872, 130484166, 34243776, 87098672, 34704576, 146344120
.long 50475840, 166857187, 51019968, 196086687, 51536320, 238095901, 67108864, 0
.long 768, 22937936, 16920704, 30605765, 33785088, 88409412, 34245888, 147654860
.long 34817792, 104269366, 50561280, 171641390, 51077632, 201264118, 51593984, 243273332
.long 86144, 4784187, 16978304, 38076983, 33787136, 147130564, 34359040, 103745070
.long 34930944, 60359576, 50618880, 175442538, 51135232, 217451752, 51679360, 234294766
.long 143744, 12255405, 17035904, 45548201, 33900288, 103220774, 34472192, 59835280
.long 34932992, 119080728, 50676480, 179243686, 51220608, 208473186, 51736960, 250482400
.long 201344, 19726623, 17121280, 27394452, 34013440, 59310984, 34474240, 118556432
.long 35046144, 75170938, 50761856, 182651606, 51278208, 212274334, 51794560, 254283548
.long 286720, 1572874, 33554688, 58786688, 34015488, 118032136, 34587392, 74646642
.long 35048192, 133892090, 50819456, 186452754, 51335808, 228461968, 51879936, 245304982
.long 344320, 9044092, 33556736, 117507840, 34128640, 74122346, 34589440, 133367794
.long 50360704, 160631174, 50877056, 190253902, 51421184, 219483402, 67108864, 0
.long 16777728, 41288296, 33669888, 73598050, 34130688, 132843498, 34702592, 89458004
.long 50418304, 164432322, 50962432, 193661822, 51478784, 223284550, 67108864, 0
.long 16835328, 48759514, 33671936, 132319202, 34243840, 88933708, 34704640, 148179156
.long 50503680, 155453756, 51020032, 197462970, 51536384, 239472184, 67108864, 0
.long 832, 24772972, 16920768, 32440801, 33785152, 90244448, 34245952, 149489896
.long 34817856, 106104402, 50561344, 172100143, 51077696, 201722871, 51594048, 243732085
.long 86208, 6619223, 16978368, 39912019, 33787200, 148965600, 34359104, 105580106
.long 34931008, 62194612, 50618944, 175901291, 51135296, 217910505, 51679424, 234753519
.long 143808, 14090441, 17035968, 47383237, 33900352, 105055810, 34472256, 61670316
.long 34933056, 120915764, 50676544, 179702439, 51220672, 208931939, 51737024, 250941153
.long 201408, 21561659, 17121344, 29229488, 34013504, 61146020, 34474304, 120391468
.long 35046208, 77005974, 50761920, 183110359, 51278272, 212733087, 51794624, 254742301
.long 286784, 3407910, 33554752, 60621724, 34015552, 119867172, 34587456, 76481678
.long 35048256, 135727126, 50819520, 186911507, 51335872, 228920721, 51880000, 245763735
.long 344384, 10879128, 33556800, 119342876, 34128704, 75957382, 34589504, 135202830
.long 50360768, 161089927, 50877120, 190712655, 51421248, 219942155, 67108864, 0
.long 16777792, 43123332, 33669952, 75433086, 34130752, 134678534, 34702656, 91293040
.long 50418368, 164891075, 50962496, 194120575, 51478848, 223743303, 67108864, 0
.long 16835392, 50594550, 33672000, 134154238, 34243904, 90768744, 34704704, 150014192
.long 50503744, 155912509, 51020096, 197921723, 51536448, 239930937, 67108864, 0
.long 28672, 983041, 16920832, 34275837, 33785216, 92079484, 34246016, 151324932
.long 34817920, 107939438, 50561408, 173476426, 51077760, 203099154, 51621888, 232328654
.long 86272, 8454259, 16978432, 41747055, 33787264, 150800636, 34359168, 107415142
.long 34931072, 64029648, 50619008, 177277574, 51163136, 206507074, 51679488, 236129802
.long 143872, 15925477, 17036032, 49218273, 33900416, 106890846, 34472320, 63505352
.long 34933120, 122750800, 50704384, 168299008, 51220736, 210308222, 51737088, 252317436
.long 201472, 23396695, 17121408, 31064524, 34013568, 62981056, 34474368, 122226504
.long 35046272, 78841010, 50761984, 184486642, 51278336, 214109370, 51794688, 256118584
.long 286848, 5242946, 33554816, 62456760, 34015616, 121702208, 34587520, 78316714
.long 35048320, 137562162, 50819584, 188287790, 51335936, 230297004, 51880064, 247140018
.long 344448, 12714164, 33556864, 121177912, 34128768, 77792418, 34589568, 137037866
.long 50360832, 162466210, 50877184, 192088938, 51421312, 221318438, 67108864, 0
.long 16777856, 44958368, 33670016, 77268122, 34130816, 136513570, 34702720, 93128076
.long 50418432, 166267358, 50962560, 195496858, 51478912, 225119586, 67108864, 0
.long 16863232, 26804619, 33672064, 135989274, 34243968, 92603780, 34704768, 151849228
.long 50503808, 157288792, 51020160, 199298006, 51536512, 241307220, 67108864, 0
.long 28736, 2818077, 16920896, 36110873, 33785280, 93914520, 34246080, 153159968
.long 34817984, 109774474, 50561472, 173935179, 51077824, 203557907, 51621952, 232787407
.long 86336, 10289295, 16978496, 43582091, 33787328, 152635672, 34359232, 109250178
.long 34931136, 65864684, 50619072, 177736327, 51163200, 206965827, 51679552, 236588555
.long 143936, 17760513, 17036096, 51053309, 33900480, 108725882, 34472384, 65340388
.long 34933184, 124585836, 50704448, 168757761, 51220800, 210766975, 51737152, 252776189
.long 201536, 25231731, 17121472, 32899560, 34013632, 64816092, 34474432, 124061540
.long 35046336, 80676046, 50762048, 184945395, 51278400, 214568123, 51794752, 256577337
.long 286912, 7077982, 33554880, 64291796, 34015680, 123537244, 34587584, 80151750
.long 35048384, 139397198, 50819648, 188746543, 51336000, 230755757, 51880128, 247598771
.long 344512, 14549200, 33556928, 123012948, 34128832, 79627454, 34589632, 138872902
.long 50360896, 162924963, 50877248, 192547691, 51421376, 221777191, 67108864, 0
.long 16777920, 46793404, 33670080, 79103158, 34130880, 138348606, 34702784, 94963112
.long 50418496, 166726111, 50962624, 195955611, 51478976, 225578339, 67108864, 0
.long 16863296, 28639655, 33672128, 137824310, 34244032, 94438816, 34704832, 153684264
.long 50503872, 157747545, 51020224, 199756759, 51536576, 241765973, 67108864, 0
.long 28800, 4653113, 16920960, 37945909, 33785344, 95749556, 34357248, 52364062
.long 34818048, 111609510, 50561536, 175311462, 51077888, 204934190, 51622016, 234163690
.long 86400, 12124331, 16978560, 45417127, 33898496, 51839766, 34359296, 111085214
.long 34931200, 67699720, 50619136, 179112610, 51163264, 208342110, 51679616, 237964838
.long 144000, 19595549, 17063936, 27263378, 33900544, 110560918, 34472448, 67175424
.long 34933248, 126420872, 50704512, 170134044, 51220864, 212143258, 51737216, 254152472
.long 229376, 1441800, 17121536, 34734596, 34013696, 66651128, 34474496, 125896576
.long 35046400, 82511082, 50762112, 186321678, 51278464, 215944406, 51822592, 245173906
.long 286976, 8913018, 33554944, 66126832, 34015744, 125372280, 34587648, 81986786
.long 35048448, 141232234, 50819712, 190122826, 51363840, 219352326, 51880192, 248975054
.long 344576, 16384236, 33556992, 124847984, 34128896, 81462490, 34589696, 140707938
.long 50360960, 164301246, 50905088, 181144260, 51421440, 223153474, 67108864, 0
.long 16777984, 48628440, 33670144, 80938194, 34130944, 140183642, 34702848, 96798148
.long 50446336, 155322680, 50962688, 197331894, 51479040, 226954622, 67108864, 0
.long 16863360, 30474691, 33672192, 139659346, 34244096, 96273852, 34816000, 52888358
.long 50503936, 159123828, 51020288, 201133042, 51536640, 243142256, 67108864, 0
.long 28864, 6488149, 16921024, 39780945, 33785408, 97584592, 34357312, 54199098
.long 34818112, 113444546, 50561600, 175770215, 51077952, 205392943, 51622080, 234622443
.long 86464, 13959367, 16978624, 47252163, 33898560, 53674802, 34359360, 112920250
.long 34931264, 69534756, 50619200, 179571363, 51163328, 208800863, 51679680, 238423591
.long 144064, 21430585, 17064000, 29098414, 33900608, 112395954, 34472512, 69010460
.long 34933312, 128255908, 50704576, 170592797, 51220928, 212602011, 51737280, 254611225
.long 229440, 3276836, 17121600, 36569632, 34013760, 68486164, 34474560, 127731612
.long 35046464, 84346118, 50762176, 186780431, 51278528, 216403159, 51822656, 245632659
.long 287040, 10748054, 33555008, 67961868, 34015808, 127207316, 34587712, 83821822
.long 35048512, 143067270, 50819776, 190581579, 51363904, 219811079, 51880256, 249433807
.long 344640, 18219272, 33557056, 126683020, 34128960, 83297526, 34589760, 142542974
.long 50361024, 164759999, 50905152, 181603013, 51421504, 223612227, 67108864, 0
.long 16778048, 50463476, 33670208, 82773230, 34131008, 142018678, 34702912, 98633184
.long 50446400, 155781433, 50962752, 197790647, 51479104, 227413375, 67108864, 0
.long 16863424, 32309727, 33672256, 141494382, 34244160, 98108888, 34816064, 54723394
.long 50504000, 159582581, 51020352, 201591795, 51536704, 243601009, 67108864, 0
.long 28928, 8323185, 16921088, 41615981, 33785472, 99419628, 34357376, 56034134
.long 34818176, 115279582, 50561664, 177146498, 51105792, 193989512, 51622144, 235998726
.long 86528, 15794403, 16978688, 49087199, 33898624, 55509838, 34359424, 114755286
.long 34931328, 71369792, 50647040, 168167932, 51163392, 210177146, 51679744, 239799874
.long 144128, 23265621, 17064064, 30933450, 33900672, 114230990, 34472576, 70845496
.long 34933376, 130090944, 50704640, 171969080, 51220992, 213978294, 51737344, 255987508
.long 229504, 5111872, 17121664, 38404668, 34013824, 70321200, 34474624, 129566648
.long 35046528, 86181154, 50762240, 188156714, 51278592, 217779442, 51822720, 247008942
.long 287104, 12583090, 33555072, 69796904, 34015872, 129042352, 34587776, 85656858
.long 35048576, 144902306, 50819840, 191957862, 51363968, 221187362, 51880320, 250810090
.long 344704, 20054308, 33557120, 128518056, 34129024, 85132562, 34589824, 144378010
.long 50361088, 166136282, 50905216, 182979296, 51421568, 224988510, 67108864, 0
.long 16805888, 26673545, 33670272, 84608266, 34131072, 143853714, 34702976, 100468220
.long 50446464, 157157716, 50962816, 199166930, 51479168, 228789658, 67108864, 0
.long 16863488, 34144763, 33672320, 143329418, 34244224, 99943924, 34816128, 56558430
.long 50504064, 160958864, 51020416, 202968078, 51564544, 232197578, 67108864, 0
.long 28992, 10158221, 16921152, 43451017, 33785536, 101254664, 34357440, 57869170
.long 34818240, 117114618, 50561728, 177605251, 51105856, 194448265, 51622208, 236457479
.long 86592, 17629439, 16978752, 50922235, 33898688, 57344874, 34359488, 116590322
.long 34931392, 73204828, 50647104, 168626685, 51163456, 210635899, 51679808, 240258627
.long 144192, 25100657, 17064128, 32768486, 33900736, 116066026, 34472640, 72680532
.long 34933440, 131925980, 50704704, 172427833, 51221056, 214437047, 51737408, 256446261
.long 229568, 6946908, 17121728, 40239704, 34013888, 72156236, 34474688, 131401684
.long 35046592, 88016190, 50762304, 188615467, 51278656, 218238195, 51822784, 247467695
.long 287168, 14418126, 33555136, 71631940, 34015936, 130877388, 34587840, 87491894
.long 35048640, 146737342, 50819904, 192416615, 51364032, 221646115, 51880384, 251268843
.long 344768, 21889344, 33557184, 130353092, 34129088, 86967598, 34589888, 146213046
.long 50361152, 166595035, 50905280, 183438049, 51421632, 225447263, 67108864, 0
.long 16805952, 28508581, 33670336, 86443302, 34131136, 145688750, 34703040, 102303256
.long 50446528, 157616469, 50962880, 199625683, 51479232, 229248411, 67108864, 0
.long 16863552, 35979799, 33672384, 145164454, 34244288, 101778960, 34816192, 58393466
.long 50504128, 161417617, 51020480, 203426831, 51564608, 232656331, 67108864, 0
.long 29056, 11993257, 16921216, 45286053, 33785600, 103089700, 34357504, 59704206
.long 34818304, 118949654, 50561792, 178981534, 51105920, 195824548, 51622272, 237833762
.long 86656, 19464475, 17006592, 27132304, 33898752, 59179910, 34359552, 118425358
.long 34931456, 75039864, 50647168, 170002968, 51163520, 212012182, 51679872, 241634910
.long 172032, 1310726, 17064192, 34603522, 33900800, 117901062, 34472704, 74515568
.long 34933504, 133761016, 50704768, 173804116, 51221120, 215813330, 51765248, 245042830
.long 229632, 8781944, 17121792, 42074740, 34013952, 73991272, 34474752, 133236720
.long 35046656, 89851226, 50762368, 189991750, 51306496, 206834764, 51822848, 248843978
.long 287232, 16253162, 33555200, 73466976, 34016000, 132712424, 34587904, 89326930
.long 35048704, 148572378, 50847744, 181013184, 51364096, 223022398, 51880448, 252645126
.long 344832, 23724380, 33557248, 132188128, 34129152, 88802634, 34589952, 148048082
.long 50388992, 155191604, 50905344, 184814332, 51421696, 226823546, 67108864, 0
.long 16806016, 30343617, 33670400, 88278338, 34131200, 147523786, 34703104, 104138292
.long 50446592, 158992752, 50962944, 201001966, 51479296, 230624694, 67108864, 0
.long 16863616, 37814835, 33672448, 146999490, 34244352, 103613996, 34816256, 60228502
.long 50504192, 162793900, 51020544, 204803114, 51564672, 234032614, 67108864, 0
.long 29120, 13828293, 16921280, 47121089, 33785664, 104924736, 34357568, 61539242
.long 34818368, 120784690, 50561856, 179440287, 51105984, 196283301, 51622336, 238292515
.long 86720, 21299511, 17006656, 28967340, 33898816, 61014946, 34359616, 120260394
.long 34931520, 76874900, 50647232, 170461721, 51163584, 212470935, 51679936, 242093663
.long 172096, 3145762, 17064256, 36438558, 33900864, 119736098, 34472768, 76350604
.long 34933568, 135596052, 50704832, 174262869, 51221184, 216272083, 51765312, 245501583
.long 229696, 10616980, 17121856, 43909776, 34014016, 75826308, 34474816, 135071756
.long 35046720, 91686262, 50762432, 190450503, 51306560, 207293517, 51822912, 249302731
.long 287296, 18088198, 33555264, 75302012, 34016064, 134547460, 34587968, 91161966
.long 35048768, 150407414, 50847808, 181471937, 51364160, 223481151, 51880512, 253103879
.long 344896, 25559416, 33557312, 134023164, 34129216, 90637670, 34590016, 149883118
.long 50389056, 155650357, 50905408, 185273085, 51421760, 227282299, 67108864, 0
.long 16806080, 32178653, 33670464, 90113374, 34131264, 149358822, 34703168, 105973328
.long 50446656, 159451505, 50963008, 201460719, 51479360, 231083447, 67108864, 0
.long 16863680, 39649871, 33672512, 148834526, 34244416, 105449032, 34816320, 62063538
.long 50504256, 163252653, 51020608, 205261867, 51564736, 234491367, 67108864, 0
.long 29184, 15663329, 16921344, 48956125, 33785728, 106759772, 34357632, 63374278
.long 34818432, 122619726, 50589696, 168036856, 51106048, 197659584, 51622400, 239668798
.long 86784, 23134547, 17006720, 30802376, 33898880, 62849982, 34359680, 122095430
.long 34931584, 78709936, 50647296, 171838004, 51163648, 213847218, 51680000, 243469946
.long 172160, 4980798, 17064320, 38273594, 33900928, 121571134, 34472832, 78185640
.long 34933632, 137431088, 50704896, 175639152, 51221248, 217648366, 51765376, 246877866
.long 229760, 12452016, 17121920, 45744812, 34014080, 77661344, 34474880, 136906792
.long 35046784, 93521298, 50762496, 191826786, 51306624, 208669800, 51822976, 250679014
.long 287360, 19923234, 33555328, 77137048, 34016128, 136382496, 34588032, 92997002
.long 35048832, 152242450, 50847872, 182848220, 51364224, 224857434, 51880576, 254480162
.long 372736, 1769485, 33557376, 135858200, 34129280, 92472706, 34590080, 151718154
.long 50389120, 157026640, 50905472, 186649368, 51421824, 228658582, 67108864, 0
.long 16806144, 34013689, 33670528, 91948410, 34131328, 151193858, 34703232, 107808364
.long 50446720, 160827788, 50963072, 202837002, 51507200, 219680016, 67108864, 0
.long 16863744, 41484907, 33672576, 150669562, 34244480, 107284068, 34816384, 63898574
.long 50504320, 164628936, 51048448, 193858436, 51564800, 235867650, 67108864, 0
.long 29248, 17498365, 16921408, 50791161, 33785792, 108594808, 34357696, 65209314
.long 34818496, 124454762, 50589760, 168495609, 51106112, 198118337, 51622464, 240127551
.long 86848, 24969583, 17006784, 32637412, 33898944, 64685018, 34359744, 123930466
.long 34931648, 80544972, 50647360, 172296757, 51163712, 214305971, 51680064, 243928699
.long 172224, 6815834, 17064384, 40108630, 33900992, 123406170, 34472896, 80020676
.long 34933696, 139266124, 50704960, 176097905, 51221312, 218107119, 51765440, 247336619
.long 229824, 14287052, 17121984, 47579848, 34014144, 79496380, 34474944, 138741828
.long 35046848, 95356334, 50762560, 192285539, 51306688, 209128553, 51823040, 251137767
.long 287424, 21758270, 33555392, 78972084, 34016192, 138217532, 34588096, 94832038
.long 35048896, 154077486, 50847936, 183306973, 51364288, 225316187, 51880640, 254938915
.long 372800, 3604521, 33557440, 137693236, 34129344, 94307742, 34590144, 153553190
.long 50389184, 157485393, 50905536, 187108121, 51421888, 229117335, 67108864, 0
.long 16806208, 35848725, 33670592, 93783446, 34131392, 153028894, 34703296, 109643400
.long 50446784, 161286541, 50963136, 203295755, 51507264, 220138769, 67108864, 0
.long 16863808, 43319943, 33672640, 152504598, 34244544, 109119104, 34816448, 65733610
.long 50504384, 165087689, 51048512, 194317189, 51564864, 236326403, 67108864, 0
.long 29312, 19333401, 16949248, 27001230, 33785856, 110429844, 34357760, 67044350
.long 34818560, 126289798, 50589824, 169871892, 51106176, 199494620, 51622528, 241503834
.long 114688, 1179652, 17006848, 34472448, 33899008, 66520054, 34359808, 125765502
.long 34931712, 82380008, 50647424, 173673040, 51163776, 215682254, 51707904, 232525268
.long 172288, 8650870, 17064448, 41943666, 33901056, 125241206, 34472960, 81855712
.long 34933760, 141101160, 50705024, 177474188, 51249152, 206703688, 51765504, 248712902
.long 229888, 16122088, 17122048, 49414884, 34014208, 81331416, 34475008, 140576864
.long 35046912, 97191370, 50790400, 180882108, 51306752, 210504836, 51823104, 252514050
.long 287488, 23593306, 33555456, 80807120, 34016256, 140052568, 34588160, 96667074
.long 50331648, 155060528, 50848000, 184683256, 51364352, 226692470, 51880704, 256315198
.long 372864, 5439557, 33557504, 139528272, 34129408, 96142778, 34701312, 52757284
.long 50389248, 158861676, 50905600, 188484404, 51421952, 230493618, 67108864, 0
.long 16806272, 37683761, 33670656, 95618482, 34242560, 52232988, 34703360, 111478436
.long 50446848, 162662824, 50963200, 204672038, 51507328, 221515052, 67108864, 0
.long 16863872, 45154979, 33783808, 51708692, 34244608, 110954140, 34816512, 67568646
.long 50504448, 166463972, 51048576, 195693472, 51564928, 237702686, 67108864, 0
.long 29376, 21168437, 16949312, 28836266, 33785920, 112264880, 34357824, 68879386
.long 34818624, 128124834, 50589888, 170330645, 51106240, 199953373, 51622592, 241962587
.long 114752, 3014688, 17006912, 36307484, 33899072, 68355090, 34359872, 127600538
.long 34931776, 84215044, 50647488, 174131793, 51163840, 216141007, 51707968, 232984021
.long 172352, 10485906, 17064512, 43778702, 33901120, 127076242, 34473024, 83690748
.long 34933824, 142936196, 50705088, 177932941, 51249216, 207162441, 51765568, 249171655
.long 229952, 17957124, 17122112, 51249920, 34014272, 83166452, 34475072, 142411900
.long 35046976, 99026406, 50790464, 181340861, 51306816, 210963589, 51823168, 252972803
.long 287552, 25428342, 33555520, 82642156, 34016320, 141887604, 34588224, 98502110
.long 50331712, 155519281, 50848064, 185142009, 51364416, 227151223, 51880768, 256773951
.long 372928, 7274593, 33557568, 141363308, 34129472, 97977814, 34701376, 54592320
.long 50389312, 159320429, 50905664, 188943157, 51422016, 230952371, 67108864, 0
.long 16806336, 39518797, 33670720, 97453518, 34242624, 54068024, 34703424, 113313472
.long 50446912, 163121577, 50963264, 205130791, 51507392, 221973805, 67108864, 0
.long 16863936, 46990015, 33783872, 53543728, 34244672, 112789176, 34816576, 69403682
.long 50504512, 166922725, 51048640, 196152225, 51564992, 238161439, 67108864, 0
.long 29440, 23003473, 16949376, 30671302, 33785984, 114099916, 34357888, 70714422
.long 34818688, 129959870, 50589952, 171706928, 51106304, 201329656, 51622656, 243338870
.long 114816, 4849724, 17006976, 38142520, 33899136, 70190126, 34359936, 129435574
.long 34931840, 86050080, 50647552, 175508076, 51163904, 217517290, 51708032, 234360304
.long 172416, 12320942, 17064576, 45613738, 33901184, 128911278, 34473088, 85525784
.long 34933888, 144771232, 50705152, 179309224, 51249280, 208538724, 51765632, 250547938
.long 230016, 19792160, 17149952, 27459989, 34014336, 85001488, 34475136, 144246936
.long 35047040, 100861442, 50790528, 182717144, 51306880, 212339872, 51823232, 254349086
.long 315392, 1638411, 33555584, 84477192, 34016384, 143722640, 34588288, 100337146
.long 50331776, 156895564, 50848128, 186518292, 51364480, 228527506, 51908608, 245370520
.long 372992, 9109629, 33557632, 143198344, 34129536, 99812850, 34701440, 56427356
.long 50389376, 160696712, 50905728, 190319440, 51449856, 219548940, 67108864, 0
.long 16806400, 41353833, 33670784, 99288554, 34242688, 55903060, 34703488, 115148508
.long 50446976, 164497860, 50991104, 193727360, 51507456, 223350088, 67108864, 0
.long 16864000, 48825051, 33783936, 55378764, 34244736, 114624212, 34816640, 71238718
.long 50532352, 167905780, 51048704, 197528508, 51565056, 239537722, 67108864, 0
.long 29504, 24838509, 16949440, 32506338, 33786048, 115934952, 34357952, 72549458
.long 34818752, 131794906, 50590016, 172165681, 51106368, 201788409, 51622720, 243797623
.long 114880, 6684760, 17007040, 39977556, 33899200, 72025162, 34360000, 131270610
.long 34931904, 87885116, 50647616, 175966829, 51163968, 217976043, 51708096, 234819057
.long 172480, 14155978, 17064640, 47448774, 33901248, 130746314, 34473152, 87360820
.long 34933952, 146606268, 50705216, 179767977, 51249344, 208997477, 51765696, 251006691
.long 230080, 21627196, 17150016, 29295025, 34014400, 86836524, 34475200, 146081972
.long 35047104, 102696478, 50790592, 183175897, 51306944, 212798625, 51823296, 254807839
.long 315456, 3473447, 33555648, 86312228, 34016448, 145557676, 34588352, 102172182
.long 50331840, 157354317, 50848192, 186977045, 51364544, 228986259, 51908672, 245829273
.long 373056, 10944665, 33557696, 145033380, 34129600, 101647886, 34701504, 58262392
.long 50389440, 161155465, 50905792, 190778193, 51449920, 220007693, 67108864, 0
.long 16806464, 43188869, 33670848, 101123590, 34242752, 57738096, 34703552, 116983544
.long 50447040, 164956613, 50991168, 194186113, 51507520, 223808841, 67108864, 0
.long 16864064, 50660087, 33784000, 57213800, 34244800, 116459248, 34816704, 73073754
.long 50532416, 168364533, 51048768, 197987261, 51565120, 239996475, 67108864, 0
.long 57344, 1048578, 16949504, 34341374, 33786112, 117769988, 34358016, 74384494
.long 34818816, 133629942, 50590080, 173541964, 51106432, 203164692, 51650560, 232394192
.long 114944, 8519796, 17007104, 41812592, 33899264, 73860198, 34360064, 133105646
.long 34931968, 89720152, 50647680, 177343112, 51191808, 206572612, 51708160, 236195340
.long 172544, 15991014, 17064704, 49283810, 33901312, 132581350, 34473216, 89195856
.long 34934016, 148441304, 50733056, 180751032, 51249408, 210373760, 51765760, 252382974
.long 230144, 23462232, 17150080, 31130061, 34014464, 88671560, 34475264, 147917008
.long 35047168, 104531514, 50790656, 184552180, 51307008, 214174908, 51823360, 256184122
.long 315520, 5308483, 33555712, 88147264, 34016512, 147392712, 34588416, 104007218
.long 50331904, 158730600, 50848256, 188353328, 51364608, 230362542, 51908736, 247205556
.long 373120, 12779701, 33557760, 146868416, 34129664, 103482922, 34701568, 60097428
.long 50389504, 162531748, 50905856, 192154476, 51449984, 221383976, 67108864, 0
.long 16806528, 45023905, 33670912, 102958626, 34242816, 59573132, 34703616, 118818580
.long 50447104, 166332896, 50991232, 195562396, 51507584, 225185124, 67108864, 0
.long 16891904, 26870156, 33784064, 59048836, 34244864, 118294284, 34816768, 74908790
.long 50532480, 169740816, 51048832, 199363544, 51565184, 241372758, 67108864, 0
.long 57408, 2883614, 16949568, 36176410, 33786176, 119605024, 34358080, 76219530
.long 34818880, 135464978, 50590144, 174000717, 51106496, 203623445, 51650624, 232852945
.long 115008, 10354832, 17007168, 43647628, 33899328, 75695234, 34360128, 134940682
.long 34932032, 91555188, 50647744, 177801865, 51191872, 207031365, 51708224, 236654093
.long 172608, 17826050, 17064768, 51118846, 33901376, 134416386, 34473280, 91030892
.long 34934080, 150276340, 50733120, 181209785, 51249472, 210832513, 51765824, 252841727
.long 230208, 25297268, 17150144, 32965097, 34014528, 90506596, 34475328, 149752044
.long 35047232, 106366550, 50790720, 185010933, 51307072, 214633661, 51823424, 256642875
.long 315584, 7143519, 33555776, 89982300, 34016576, 149227748, 34588480, 105842254
.long 50331968, 159189353, 50848320, 188812081, 51364672, 230821295, 51908800, 247664309
.long 373184, 14614737, 33557824, 148703452, 34129728, 105317958, 34701632, 61932464
.long 50389568, 162990501, 50905920, 192613229, 51450048, 221842729, 67108864, 0
.long 16806592, 46858941, 33670976, 104793662, 34242880, 61408168, 34703680, 120653616
.long 50447168, 166791649, 50991296, 196021149, 51507648, 225643877, 67108864, 0
.long 16891968, 28705192, 33784128, 60883872, 34244928, 120129320, 34816832, 76743826
.long 50532544, 170199569, 51048896, 199822297, 51565248, 241831511, 67108864, 0
.long 57472, 4718650, 16949632, 38011446, 33786240, 121440060, 34358144, 78054566
.long 34818944, 137300014, 50590208, 175377000, 51106560, 204999728, 51650688, 234229228
.long 115072, 12189868, 17007232, 45482664, 33899392, 77530270, 34360192, 136775718
.long 34932096, 93390224, 50647808, 179178148, 51191936, 208407648, 51708288, 238030376
.long 172672, 19661086, 17092608, 27328915, 33901440, 136251422, 34473344, 92865928
.long 34934144, 152111376, 50733184, 182586068, 51249536, 212208796, 51765888, 254218010
.long 258048, 1507337, 17150208, 34800133, 34014592, 92341632, 34475392, 151587080
.long 35047296, 108201586, 50790784, 186387216, 51307136, 216009944, 51851264, 245239444
.long 315648, 8978555, 33555840, 91817336, 34016640, 151062784, 34588544, 107677290
.long 50332032, 160565636, 50848384, 190188364, 51392512, 219417864, 51908864, 249040592
.long 373248, 16449773, 33557888, 150538488, 34129792, 107152994, 34701696, 63767500
.long 50389632, 164366784, 50933760, 193596284, 51450112, 223219012, 67108864, 0
.long 16806656, 48693977, 33671040, 106628698, 34242944, 63243204, 34703744, 122488652
.long 50475008, 155388218, 50991360, 197397432, 51507712, 227020160, 67108864, 0
.long 16892032, 30540228, 33784192, 62718908, 34244992, 121964356, 34816896, 78578862
.long 50532608, 171575852, 51048960, 201198580, 51565312, 243207794, 67108864, 0
.long 57536, 6553686, 16949696, 39846482, 33786304, 123275096, 34358208, 79889602
.long 34819008, 139135050, 50590272, 175835753, 51106624, 205458481, 51650752, 234687981
.long 115136, 14024904, 17007296, 47317700, 33899456, 79365306, 34360256, 138610754
.long 34932160, 95225260, 50647872, 179636901, 51192000, 208866401, 51708352, 238489129
.long 172736, 21496122, 17092672, 29163951, 33901504, 138086458, 34473408, 94700964
.long 34934208, 153946412, 50733248, 183044821, 51249600, 212667549, 51765952, 254676763
.long 258112, 3342373, 17150272, 36635169, 34014656, 94176668, 34475456, 153422116
.long 35047360, 110036622, 50790848, 186845969, 51307200, 216468697, 51851328, 245698197
.long 315712, 10813591, 33555904, 93652372, 34016704, 152897820, 34588608, 109512326
.long 50332096, 161024389, 50848448, 190647117, 51392576, 219876617, 51908928, 249499345
.long 373312, 18284809, 33557952, 152373524, 34129856, 108988030, 34701760, 65602536
.long 50389696, 164825537, 50933824, 194055037, 51450176, 223677765, 67108864, 0
.long 16806720, 50529013, 33671104, 108463734, 34243008, 65078240, 34703808, 124323688
.long 50475072, 155846971, 50991424, 197856185, 51507776, 227478913, 67108864, 0
.long 16892096, 32375264, 33784256, 64553944, 34245056, 123799392, 34816960, 80413898
.long 50532672, 172034605, 51049024, 201657333, 51565376, 243666547, 67108864, 0
.size tap_table, 22656
.section .rodata,"a"
.p2align 6
.amdhsa_kernel sequential_preLN__ssm_conv_s4d__mixer_s_mlp__prompt_kernel
  .amdhsa_next_free_vgpr 256
  .amdhsa_next_free_sgpr 102
  .amdhsa_accum_offset 256
  .amdhsa_group_segment_fixed_size 0
  .amdhsa_kernarg_size 120
  .amdhsa_user_sgpr_count 2
  .amdhsa_user_sgpr_kernarg_segment_ptr 1
  .amdhsa_system_sgpr_workgroup_id_x 1
.end_amdhsa_kernel
```
